```python
import torch

def _softmax(x, axis=-1):
    return torch.softmax(x, dim=axis)
def _gelu(x):
    return torch.nn.functional.gelu(x, approximate="tanh")
def _silu(x):
    return torch.nn.functional.silu(x)
def _sigmoid(x):
    return torch.sigmoid(x)
def _layernorm(x, axis=-1, eps=1e-5):
    m = x.mean(dim=axis, keepdim=True)
    v = x.var(dim=axis, keepdim=True, unbiased=False)
    return (x - m) / torch.sqrt(v + eps)
def _scatter_add(tgt, idx, src, axis=0):
    return tgt.clone().index_add_(axis, idx, src)
def _segment_sum(src, seg, n):
    out = torch.zeros((n,) + src.shape[1:], dtype=src.dtype)
    return out.index_add_(0, seg, src)
def _pad(x, pw):
    flat = tuple(v for pair in reversed(pw) for v in pair)
    return torch.nn.functional.pad(x, flat)

kernel_name = 'recurrent_scan__mha_block_cached__geglu_ffn__decode'

def setup_inputs():

    _w = (lambda a: (lambda t: t.to(torch.bfloat16) if t.is_floating_point() else t)(torch.as_tensor(a)))
    def _A_setup():
        B, Sq, D = 2, 1, 512
        H, Sk, Dh = 32, 8192, 128
        return {
            "x": _w((lambda *s: torch.randn(*s, dtype=torch.bfloat16) * 0.05)(B, Sq, D)),
            "k_cache": _w((lambda *s: torch.randn(*s, dtype=torch.bfloat16) * 1.6)(B, H, Sk, Dh)),
            "v_cache": _w((lambda *s: torch.randn(*s, dtype=torch.bfloat16) * 0.2)(B, H, Sk, Dh)),
            "wq": _w((lambda *s: torch.randn(*s, dtype=torch.bfloat16) * 1.6)(D, H * Dh) * (D ** -0.5)),
            "wo": _w((lambda *s: torch.randn(*s, dtype=torch.bfloat16) * 0.2)(H * Dh, D) * ((H * Dh) ** -0.5)),
        }
    _A_in = _A_setup()

    def _B_setup():
        B, S, D, F = 2, 1, 512, 1376
        return {
            "x": _w((lambda *s: torch.randn(*s, dtype=torch.bfloat16) * 0.05)(B, S, D)),
            "w_gate": _w((lambda *s: torch.randn(*s, dtype=torch.bfloat16) * 0.1)(D, F)),
            "w_up": _w((lambda *s: torch.randn(*s, dtype=torch.bfloat16) * 0.1)(D, F)),
            "w_down": _w((lambda *s: torch.randn(*s, dtype=torch.bfloat16) * 0.1)(F, D)),
        }
    _B_in = _B_setup()

    return {
        "A_x": _A_in["x"],
        "A_k_cache": _A_in["k_cache"],
        "A_v_cache": _A_in["v_cache"],
        "A_wq": _A_in["wq"],
        "A_wo": _A_in["wo"],
        "B_x": _B_in["x"],
        "B_w_gate": _B_in["w_gate"],
        "B_w_up": _B_in["w_up"],
        "B_w_down": _B_in["w_down"],
    }

def reference(A_x, A_k_cache, A_v_cache, A_wq, A_wo, B_x, B_w_gate, B_w_up, B_w_down):
    def _A_ref(x, k_cache, v_cache, wq, wo):
        B, Sq, D = x.shape
        H, Dh = 32, 128
        q = (lambda x, *d: x.permute(*d))((x @ wq).reshape(B, Sq, H, Dh), 0, 2, 1, 3)
        scores = torch.einsum("bhqd,bhkd->bhqk", q, k_cache) * (Dh ** -0.5)
        p = _softmax(scores, axis=-1)
        o = torch.einsum("bhqk,bhkd->bhqd", p, v_cache)
        return (lambda x, *d: x.permute(*d))(o, 0, 2, 1, 3).reshape(B, Sq, H * Dh) @ wo

    def _B_ref(x, w_gate, w_up, w_down):
        return (_gelu(x @ w_gate) * (x @ w_up)) @ w_down

    x = A_x
    xn = _layernorm(x, axis=-1)
    s = _A_ref(xn, A_k_cache, A_v_cache, A_wq, A_wo)
    g = _silu(_B_ref(xn, B_w_gate, B_w_up, B_w_down))
    return x + s * g
```

```asm
; @launch grid=(256,1,1) block=(512,1,1) lds=32768
.amdgcn_target "amdgcn-amd-amdhsa--gfx950"
.text
.globl recurrent_scan__mha_block_cached__geglu_ffn__decode_kernel
.p2align 8
.type recurrent_scan__mha_block_cached__geglu_ffn__decode_kernel,@function
recurrent_scan__mha_block_cached__geglu_ffn__decode_kernel:
    s_cmp_ge_u32 s2, 256
    s_cbranch_scc1 L_exit
    s_getpc_b64 s[70:71]
    s_load_dwordx2 s[4:5], s[0:1], 0
    s_load_dwordx2 s[8:9], s[0:1], 8
    s_load_dwordx2 s[16:17], s[0:1], 24
    s_load_dwordx4 s[44:47], s[0:1], 48
    s_load_dwordx2 s[12:13], s[0:1], 16
    s_load_dwordx2 s[28:29], s[0:1], 64
    s_load_dwordx2 s[20:21], s[0:1], 32
    s_load_dwordx2 s[32:33], s[0:1], 72
    s_load_dwordx2 s[36:37], s[0:1], 80
    s_load_dwordx2 s[40:41], s[0:1], 88
    v_lshrrev_b32 v56, 6, v0
    v_and_b32 v1, 63, v0
    v_readfirstlane_b32 s54, v56
    v_lshlrev_b32 v122, 7, v0
    v_cmp_gt_u32 vcc, 120, v0
    s_nop 0
    s_and_saveexec_b64 s[72:73], vcc
    s_cbranch_execz L_nocpf
    global_load_dword v123, v122, s[70:71]
L_nocpf:
    s_mov_b64 exec, s[72:73]
    s_mov_b32 s6, 0x800
    s_mov_b32 s7, 0x00020000
    s_mov_b32 s10, 0x8000000
    s_mov_b32 s11, 0x00020000
    s_mov_b32 s14, 0x8000000
    s_mov_b32 s15, 0x00020000
    s_mov_b32 s18, 0x400000
    s_mov_b32 s19, 0x00020000
    s_mov_b32 s22, 0x400000
    s_mov_b32 s23, 0x00020000
    s_mov_b32 s26, 0x158000
    s_mov_b32 s27, 0x00020000
    s_mov_b32 s30, 0x158000
    s_mov_b32 s31, 0x00020000
    s_mov_b32 s34, 0x800
    s_mov_b32 s35, 0x00020000
    s_mov_b32 s38, 0x100
    s_mov_b32 s39, 0x00020000
    s_mov_b32 s42, 0x400000
    s_mov_b32 s43, 0x00020000
    s_and_b32 s48, s2, 7
    s_lshr_b32 s49, s2, 3
    s_lshr_b32 s61, s49, 3
    s_lshl_b32 s50, s48, 2
    s_add_u32 s50, s50, s61
    s_bfe_u32 s51, s49, 0x10002
    s_and_b32 s52, s49, 3
    s_and_b32 s70, s49, 7
    s_lshl_b32 s53, s51, 5
    s_add_u32 s53, s53, s50
    v_lshlrev_b32 v2, 4, v1
    v_lshrrev_b32 v5, 4, v1
    v_and_b32 v6, 15, v1
    s_lshl_b32 s61, s53, 21
    s_lshl_b32 s62, s54, 12
    s_add_u32 s61, s61, s62
    v_add_u32 v17, s61, v2
    s_mul_i32 s64, s53, 4
    s_add_u32 s64, s64, s52
    s_lshl_b32 s63, s70, 3
    s_add_u32 s63, s63, s54
    s_lshl_b32 s63, s63, 3
    s_lshl_b32 s57, s63, 13
    s_lshl_b32 s62, s50, 8
    s_add_u32 s57, s57, s62
    s_add_u32 s65, s57, 32768
    v_lshlrev_b32 v57, 13, v5
    v_lshl_add_u32 v57, v6, 4, v57
    s_cmp_lt_u32 s50, 22
    s_cselect_b32 s71, 0, 0x80000000
    s_sub_u32 s68, s50, 11
    s_cmp_lt_u32 s50, 11
    s_cselect_b32 s66, s50, s68
    s_mul_i32 s62, s63, 2752
    s_lshl_b32 s68, s66, 8
    s_add_u32 s62, s62, s68
    s_or_b32 s62, s62, s71
    v_mul_u32_u24 v58, 2752, v5
    v_lshl_add_u32 v58, v6, 4, v58
    v_add_u32 v58, s62, v58
    v_and_b32 v59, 1, v6
    v_lshl_add_u32 v59, v59, 2, v5
    v_add_lshl_u32 v59, v59, s63, 1
    s_add_u32 s61, s64, 0
    s_add_u32 s96, s61, 0
    s_and_b32 s96, s96, 63
    s_lshl_b32 s96, s96, 15
    s_add_u32 s97, s61, 4
    s_and_b32 s97, s97, 63
    s_lshl_b32 s97, s97, 15
    s_add_u32 s98, s61, 8
    s_and_b32 s98, s98, 63
    s_lshl_b32 s98, s98, 15
    s_add_u32 s99, s61, 12
    s_and_b32 s99, s99, 63
    s_lshl_b32 s99, s99, 15
    s_waitcnt lgkmcnt(0)
    s_mov_b32 s61, 0x1b8000
    s_load_dword s56, s[40:41], s61
    s_cmp_lt_u32 s50, 11
    s_cselect_b32 s24, s44, s46
    s_cselect_b32 s25, s45, s47
    buffer_load_dwordx4 v[192:195], v17, s[8:11], s96 offen nt
    buffer_load_dwordx4 v[68:71], v2, s[4:7], 0 offen
    buffer_load_dwordx4 v[72:75], v2, s[4:7], 0 offen offset:1024
    buffer_load_ushort v60, v59, s[4:7], 0 offen
    buffer_load_ushort v61, v59, s[4:7], 0 offen offset:1024
    buffer_load_dwordx4 v[76:79], v57, s[16:19], s57 offen nt
    buffer_load_dwordx4 v[80:83], v57, s[16:19], s65 offen nt
    s_movk_i32 s62, 11008
    buffer_load_dwordx4 v[84:87], v58, s[24:27], 0 offen nt
    buffer_load_dwordx4 v[88:91], v58, s[24:27], s62 offen nt
    buffer_load_dwordx4 v[196:199], v17, s[8:11], s96 offen offset:1024 nt
    buffer_load_dwordx4 v[200:203], v17, s[8:11], s96 offen offset:2048 nt
    s_mov_b32 s61, 0x95438210
    s_lshl_b32 s62, s70, 2
    s_lshr_b32 s61, s61, s62
    s_and_b32 s61, s61, 15
    s_lshr_b32 s79, s61, 3
    s_lshr_b32 s62, s49, 3
    s_mul_i32 s67, s62, 6
    s_add_u32 s67, s67, s61
    s_lshl_b32 s62, s62, 1
    s_and_b32 s61, s61, 1
    s_add_u32 s62, s62, s61
    s_lshl_b32 s62, s62, 3
    s_add_u32 s3, s62, s48
    s_lshl_b32 s76, s53, 2
    s_add_u32 s76, s76, s52
    s_lshl_b32 s60, s67, 3
    s_add_u32 s60, s60, s48
    s_cmp_eq_u32 s79, 1
    s_cselect_b32 s60, 255, s60
    s_cmp_lt_u32 s60, 172
    s_cselect_b32 s78, s54, 8
    s_lshl_b32 s75, s70, 1
    s_and_b32 s63, s54, 3
    v_add_u32 v127, s75, v6
    v_and_b32 v127, 15, v127
    v_mov_b32 v3, 0
    v_lshlrev_b32 v4, 10, v5
    v_lshl_add_u32 v4, v6, 4, v4
    s_lshl_b32 s58, s50, 17
    s_lshr_b32 s62, s54, 2
    s_lshl_b32 s62, s62, 16
    s_add_u32 s58, s58, s62
    s_lshl_b32 s62, s63, 8
    s_add_u32 s58, s58, s62
    s_lshl_b32 s59, s60, 13
    s_add_u32 s59, s59, s62
    s_lshl_b32 s62, s76, 11
    s_lshl_b32 s68, s54, 10
    s_add_u32 s62, s62, s68
    s_cmp_lt_u32 s54, 2
    s_cselect_b32 s62, s62, 0x80000000
    v_add_u32 v34, s62, v2
    s_lshl_b32 s62, s76, 3
    s_add_u32 s62, s62, 0x1b0000
    v_mov_b32 v35, s62
    v_mov_b32 v56, 0x80000000
    v_cmp_eq_u32 vcc, 0, v0
    s_nop 1
    v_cndmask_b32 v35, v56, v35, vcc
    v_lshrrev_b32 v56, 1, v5
    v_and_b32 v62, 1, v5
    v_lshlrev_b32 v62, 4, v62
    v_lshl_add_u32 v62, v6, 5, v62
    v_lshl_add_u32 v126, v56, 9, v62
    s_lshl_b32 s62, s60, 12
    s_add_u32 s62, s62, 0x100000
    s_lshl_b32 s68, s63, 9
    s_add_u32 s62, s62, s68
    v_lshl_add_u32 v36, v56, 11, v62
    v_add_u32 v36, s62, v36
    s_mov_b32 s72, 0x3fb8aa3b
    s_mov_b32 s73, 0x3db504f3
    s_mov_b32 s74, 0xffff0000
    s_mov_b32 s44, 0xaaaaaaaa
    s_mov_b32 s45, 0xaaaaaaaa
    s_mov_b32 s46, 0xcccccccc
    s_mov_b32 s47, 0xcccccccc
    v_lshrrev_b32 v56, 3, v6
    v_mul_u32_u24 v56, 0x0202, v56
    v_add_u32 v56, 0x0100, v56
    v_and_b32 v57, 1, v6
    v_lshlrev_b32 v57, 4, v57
    v_lshlrev_b32 v56, v57, v56
    v_mov_b32 v62, 0x0c0c0000
    v_lshrrev_b32 v62, v57, v62
    v_or_b32 v56, v56, v62
    v_bfe_u32 v63, v6, 1, 2
    v_mov_b32 v62, 0x0c0c0c0c
    v_cmp_eq_u32 vcc, 0, v63
    s_nop 1
    v_cndmask_b32 v8, v62, v56, vcc
    v_cmp_eq_u32 vcc, 1, v63
    s_nop 1
    v_cndmask_b32 v9, v62, v56, vcc
    v_cmp_eq_u32 vcc, 2, v63
    s_nop 1
    v_cndmask_b32 v10, v62, v56, vcc
    v_cmp_eq_u32 vcc, 3, v63
    s_nop 1
    v_cndmask_b32 v11, v62, v56, vcc
    v_and_b32 v56, 1, v5
    v_lshlrev_b32 v56, 2, v56
    v_lshl_add_u32 v56, v6, 3, v56
    v_lshrrev_b32 v57, 1, v5
    v_add_u32 v7, v56, v57
    s_waitcnt vmcnt(8)
    v_lshlrev_b32 v96, 16, v68
    v_and_b32 v97, s74, v68
    v_lshlrev_b32 v98, 16, v69
    v_and_b32 v99, s74, v69
    v_lshlrev_b32 v100, 16, v70
    v_and_b32 v101, s74, v70
    v_lshlrev_b32 v102, 16, v71
    v_and_b32 v103, s74, v71
    v_lshlrev_b32 v104, 16, v72
    v_and_b32 v105, s74, v72
    v_lshlrev_b32 v106, 16, v73
    v_and_b32 v107, s74, v73
    v_lshlrev_b32 v108, 16, v74
    v_and_b32 v109, s74, v74
    v_lshlrev_b32 v110, 16, v75
    v_and_b32 v111, s74, v75
    v_add_f32 v112, v96, v97
    v_add_f32 v114, v98, v99
    v_add_f32 v113, v104, v105
    v_add_f32 v115, v106, v107
    v_add_f32 v112, v112, v100
    v_add_f32 v114, v114, v101
    v_add_f32 v113, v113, v108
    v_add_f32 v115, v115, v109
    v_add_f32 v112, v112, v102
    v_add_f32 v114, v114, v103
    v_add_f32 v113, v113, v110
    v_add_f32 v115, v115, v111
    v_add_f32 v112, v112, v114
    v_add_f32 v113, v113, v115
    s_nop 0
    v_add_f32_dpp v112, v112, v112 quad_perm:[1,0,3,2] row_mask:0xf bank_mask:0xf
    v_add_f32_dpp v113, v113, v113 quad_perm:[1,0,3,2] row_mask:0xf bank_mask:0xf
    s_nop 0
    v_add_f32_dpp v112, v112, v112 quad_perm:[2,3,0,1] row_mask:0xf bank_mask:0xf
    v_add_f32_dpp v113, v113, v113 quad_perm:[2,3,0,1] row_mask:0xf bank_mask:0xf
    s_nop 0
    v_add_f32_dpp v112, v112, v112 row_half_mirror row_mask:0xf bank_mask:0xf
    v_add_f32_dpp v113, v113, v113 row_half_mirror row_mask:0xf bank_mask:0xf
    s_nop 0
    v_add_f32_dpp v112, v112, v112 row_mirror row_mask:0xf bank_mask:0xf
    v_add_f32_dpp v113, v113, v113 row_mirror row_mask:0xf bank_mask:0xf
    v_mov_b32 v114, v112
    v_mov_b32 v115, v113
    s_nop 0
    v_permlane16_swap_b32 v112, v114
    v_permlane16_swap_b32 v113, v115
    v_add_f32 v112, v112, v114
    v_add_f32 v113, v113, v115
    v_mov_b32 v114, v112
    v_mov_b32 v115, v113
    s_nop 0
    v_permlane32_swap_b32 v112, v114
    v_permlane32_swap_b32 v113, v115
    v_add_f32 v112, v112, v114
    v_add_f32 v113, v113, v115
    v_mul_f32 v116, 0x3b000000, v112
    v_mul_f32 v117, 0x3b000000, v113
    v_sub_f32 v96, v96, v116
    v_sub_f32 v97, v97, v116
    v_sub_f32 v98, v98, v116
    v_sub_f32 v99, v99, v116
    v_sub_f32 v100, v100, v116
    v_sub_f32 v101, v101, v116
    v_sub_f32 v102, v102, v116
    v_sub_f32 v103, v103, v116
    v_sub_f32 v104, v104, v117
    v_sub_f32 v105, v105, v117
    v_sub_f32 v106, v106, v117
    v_sub_f32 v107, v107, v117
    v_sub_f32 v108, v108, v117
    v_sub_f32 v109, v109, v117
    v_sub_f32 v110, v110, v117
    v_sub_f32 v111, v111, v117
    v_mul_f32 v112, v96, v96
    v_mul_f32 v114, v97, v97
    v_mul_f32 v113, v104, v104
    v_mul_f32 v115, v105, v105
    v_fmac_f32 v112, v98, v98
    v_fmac_f32 v114, v99, v99
    v_fmac_f32 v113, v106, v106
    v_fmac_f32 v115, v107, v107
    v_fmac_f32 v112, v100, v100
    v_fmac_f32 v114, v101, v101
    v_fmac_f32 v113, v108, v108
    v_fmac_f32 v115, v109, v109
    v_fmac_f32 v112, v102, v102
    v_fmac_f32 v114, v103, v103
    v_fmac_f32 v113, v110, v110
    v_fmac_f32 v115, v111, v111
    v_add_f32 v112, v112, v114
    v_add_f32 v113, v113, v115
    s_nop 0
    v_add_f32_dpp v112, v112, v112 quad_perm:[1,0,3,2] row_mask:0xf bank_mask:0xf
    v_add_f32_dpp v113, v113, v113 quad_perm:[1,0,3,2] row_mask:0xf bank_mask:0xf
    s_nop 0
    v_add_f32_dpp v112, v112, v112 quad_perm:[2,3,0,1] row_mask:0xf bank_mask:0xf
    v_add_f32_dpp v113, v113, v113 quad_perm:[2,3,0,1] row_mask:0xf bank_mask:0xf
    s_nop 0
    v_add_f32_dpp v112, v112, v112 row_half_mirror row_mask:0xf bank_mask:0xf
    v_add_f32_dpp v113, v113, v113 row_half_mirror row_mask:0xf bank_mask:0xf
    s_nop 0
    v_add_f32_dpp v112, v112, v112 row_mirror row_mask:0xf bank_mask:0xf
    v_add_f32_dpp v113, v113, v113 row_mirror row_mask:0xf bank_mask:0xf
    v_mov_b32 v114, v112
    v_mov_b32 v115, v113
    s_nop 0
    v_permlane16_swap_b32 v112, v114
    v_permlane16_swap_b32 v113, v115
    v_add_f32 v112, v112, v114
    v_add_f32 v113, v113, v115
    v_mov_b32 v114, v112
    v_mov_b32 v115, v113
    s_nop 0
    v_permlane32_swap_b32 v112, v114
    v_permlane32_swap_b32 v113, v115
    v_add_f32 v112, v112, v114
    v_add_f32 v113, v113, v115
    v_mul_f32 v112, 0x3b000000, v112
    v_mul_f32 v113, 0x3b000000, v113
    v_alignbit_b32 v19, v112, v112, 11
    v_xor_b32 v19, v19, v116
    v_alignbit_b32 v19, v19, v19, 7
    v_xor_b32 v19, v19, v113
    v_alignbit_b32 v19, v19, v19, 13
    v_xor_b32 v19, v19, v117
    s_nop 0
    v_readfirstlane_b32 s61, v19
    s_waitcnt lgkmcnt(0)
    s_add_u32 s56, s56, 0x9e3779b9
    s_add_u32 s61, s61, s56
    v_mov_b32 v19, s61
    v_cvt_pk_bf16_f32 v118, v116, v117
    v_lshlrev_b32 v116, 16, v118
    v_and_b32 v117, s74, v118
    v_cvt_pk_bf16_f32 v118, v112, v113
    v_lshlrev_b32 v112, 16, v118
    v_and_b32 v113, s74, v118
    v_add_f32 v112, 0x3727c5ac, v112
    v_add_f32 v113, 0x3727c5ac, v113
    v_cvt_pk_bf16_f32 v118, v112, v113
    v_lshlrev_b32 v112, 16, v118
    v_and_b32 v113, s74, v118
    v_sqrt_f32 v112, v112
    v_sqrt_f32 v113, v113
    s_nop 0
    v_cvt_pk_bf16_f32 v118, v112, v113
    v_lshlrev_b32 v112, 16, v118
    v_and_b32 v113, s74, v118
    v_rcp_f32 v119, v112
    v_rcp_f32 v120, v113
    s_waitcnt vmcnt(6)
    v_lshlrev_b32 v60, 16, v60
    v_lshlrev_b32 v61, 16, v61
    v_sub_f32 v60, v60, v116
    v_sub_f32 v61, v61, v117
    v_cvt_pk_bf16_f32 v118, v60, v61
    v_lshlrev_b32 v60, 16, v118
    v_and_b32 v61, s74, v118
    v_mul_f32 v60, v60, v119
    v_mul_f32 v61, v61, v120
    v_cvt_pk_bf16_f32 v37, v60, v61
    s_nop 1
    v_mov_b32_dpp v32, v37 row_newbcast:0 row_mask:0xf bank_mask:0xf
    v_perm_b32 v24, v32, v32, v8
    v_perm_b32 v25, v32, v32, v9
    v_perm_b32 v26, v32, v32, v10
    v_perm_b32 v27, v32, v32, v11
    v_mov_b32_dpp v33, v37 row_newbcast:1 row_mask:0xf bank_mask:0xf
    v_perm_b32 v28, v33, v33, v8
    v_perm_b32 v29, v33, v33, v9
    v_perm_b32 v30, v33, v33, v10
    v_perm_b32 v31, v33, v33, v11
    s_lshl_b32 s61, s54, 10
    v_add_u32 v62, s61, v126
    s_waitcnt vmcnt(2)
    v_mfma_f32_16x16x32_bf16 v[96:99], v[24:27], v[76:79], 0
    v_mfma_f32_16x16x32_bf16 v[100:103], v[24:27], v[84:87], 0
    v_mfma_f32_16x16x32_bf16 v[96:99], v[28:31], v[80:83], v[96:99]
    v_mfma_f32_16x16x32_bf16 v[100:103], v[28:31], v[88:91], v[100:103]
    buffer_load_dwordx4 v[204:207], v17, s[8:11], s96 offen offset:3072 nt
    buffer_load_dwordx4 v[208:211], v17, s[8:11], s97 offen nt
    buffer_load_dwordx4 v[212:215], v17, s[8:11], s97 offen offset:1024 nt
    s_nop 3
    ds_write_b128 v62, v[96:99] offset:16384
    ds_write_b128 v62, v[100:103] offset:24576
    ds_write_b32 v3, v3 offset:5248
    ds_write_b32 v3, v3 offset:5252
    s_waitcnt lgkmcnt(0)
    s_barrier
    s_cmp_ge_u32 s54, 2
    s_cbranch_scc1 L_el0
    s_lshl_b32 s61, s54, 13
    v_add_u32 v62, s61, v2
    ds_read_b128 v[68:71], v62 offset:16384
    ds_read_b128 v[72:75], v62 offset:17408
    ds_read_b128 v[76:79], v62 offset:18432
    ds_read_b128 v[80:83], v62 offset:19456
    ds_read_b128 v[84:87], v62 offset:20480
    ds_read_b128 v[88:91], v62 offset:21504
    ds_read_b128 v[92:95], v62 offset:22528
    ds_read_b128 v[96:99], v62 offset:23552
    s_lshl_b32 s61, s50, 3
    s_add_u32 s61, s61, s70
    s_lshl_b32 s61, s61, 11
    s_add_u32 s62, s61, 0x380000
    s_or_b32 s62, s62, s71
    s_add_u32 s61, s61, 0x80000
    s_cmp_eq_u32 s54, 0
    s_cselect_b32 s61, s61, s62
    v_add_u32 v63, s61, v2
    v_mov_b32 v100, -1
    v_mov_b32 v101, -1
    v_mov_b32 v102, -1
    v_mov_b32 v103, -1
    s_waitcnt lgkmcnt(0)
    v_add_f32 v68, v68, v72
    v_add_f32 v69, v69, v73
    v_add_f32 v70, v70, v74
    v_add_f32 v71, v71, v75
    v_add_f32 v76, v76, v80
    v_add_f32 v77, v77, v81
    v_add_f32 v78, v78, v82
    v_add_f32 v79, v79, v83
    v_add_f32 v84, v84, v88
    v_add_f32 v85, v85, v89
    v_add_f32 v86, v86, v90
    v_add_f32 v87, v87, v91
    v_add_f32 v92, v92, v96
    v_add_f32 v93, v93, v97
    v_add_f32 v94, v94, v98
    v_add_f32 v95, v95, v99
    v_add_f32 v68, v68, v76
    v_add_f32 v69, v69, v77
    v_add_f32 v70, v70, v78
    v_add_f32 v71, v71, v79
    v_add_f32 v84, v84, v92
    v_add_f32 v85, v85, v93
    v_add_f32 v86, v86, v94
    v_add_f32 v87, v87, v95
    v_add_f32 v72, v68, v84
    v_mov_b32 v73, v19
    v_add_f32 v74, v69, v85
    v_mov_b32 v75, v19
    v_add_f32 v76, v70, v86
    v_mov_b32 v77, v19
    v_add_f32 v78, v71, v87
    v_mov_b32 v79, v19
    buffer_store_dwordx4 v[72:75], v63, s[40:43], 0 offen sc1
    buffer_store_dwordx4 v[76:79], v63, s[40:43], 0 offen offset:1024 sc1
    buffer_store_dwordx4 v[100:103], v34, s[40:43], 0 offen sc1
    buffer_store_dwordx2 v[100:101], v35, s[40:43], 0 offen sc1
    buffer_load_dwordx4 v[216:219], v17, s[8:11], s97 offen offset:2048 nt
    buffer_load_dwordx4 v[220:223], v17, s[8:11], s97 offen offset:3072 nt
    buffer_load_dwordx4 v[224:227], v17, s[8:11], s98 offen nt
    buffer_load_dwordx4 v[228:231], v17, s[8:11], s98 offen offset:1024 nt
    s_branch L_jn0
L_el0:
    s_waitcnt vmcnt(2)
    buffer_load_dwordx4 v[216:219], v17, s[8:11], s97 offen offset:2048 nt
    s_waitcnt vmcnt(2)
    buffer_load_dwordx4 v[220:223], v17, s[8:11], s97 offen offset:3072 nt
    s_waitcnt vmcnt(2)
    buffer_load_dwordx4 v[224:227], v17, s[8:11], s98 offen nt
    s_waitcnt vmcnt(2)
    buffer_load_dwordx4 v[228:231], v17, s[8:11], s98 offen offset:1024 nt
L_jn0:
    s_nop 1
    s_lshl_b32 s61, s50, 17
    s_lshl_b32 s62, s70, 14
    s_add_u32 s61, s61, s62
    s_lshl_b32 s62, s54, 11
    s_add_u32 s68, s61, s62
    v_lshlrev_b32 v64, 1, v2
    s_mov_b32 s18, 0
    s_lshl_b32 s55, s50, 14
    s_lshl_b32 s62, s54, 11
    s_add_u32 s55, s55, s62
    s_lshl_b32 s62, s51, 9
    s_add_u32 s55, s55, s62
    s_add_u32 s55, s55, 0x80000
    v_lshrrev_b32 v60, 5, v1
    v_lshl_add_u32 v61, v60, 9, v2
    v_and_b32 v62, 31, v1
    v_lshlrev_b32 v62, 4, v62
    v_lshl_add_u32 v60, v60, 3, v62
    s_lshl_b32 s62, s54, 9
    s_add_u32 s62, s62, 0
    v_add_u32 v60, s62, v60
    s_mov_b32 s77, 0
    s_waitcnt vmcnt(2)
    buffer_load_dwordx4 v[232:235], v17, s[8:11], s98 offen offset:2048 nt
    s_waitcnt vmcnt(2)
    buffer_load_dwordx4 v[236:239], v17, s[8:11], s98 offen offset:3072 nt
    s_waitcnt vmcnt(2)
    buffer_load_dwordx4 v[240:243], v17, s[8:11], s99 offen nt
    s_waitcnt vmcnt(2)
    buffer_load_dwordx4 v[244:247], v17, s[8:11], s99 offen offset:1024 nt
    s_waitcnt vmcnt(2)
    buffer_load_dwordx4 v[248:251], v17, s[8:11], s99 offen offset:2048 nt
    s_waitcnt vmcnt(2)
    buffer_load_dwordx4 v[252:255], v17, s[8:11], s99 offen offset:3072 nt
    s_add_u32 s61, s64, 16
    s_add_u32 s96, s61, 0
    s_and_b32 s96, s96, 63
    s_lshl_b32 s96, s96, 15
    s_add_u32 s97, s61, 4
    s_and_b32 s97, s97, 63
    s_lshl_b32 s97, s97, 15
    s_add_u32 s98, s61, 8
    s_and_b32 s98, s98, 63
    s_lshl_b32 s98, s98, 15
    s_add_u32 s99, s61, 12
    s_and_b32 s99, s99, 63
    s_lshl_b32 s99, s99, 15
    s_waitcnt vmcnt(2)
    buffer_load_dwordx4 v[128:131], v17, s[8:11], s96 offen nt
    s_waitcnt vmcnt(2)
    buffer_load_dwordx4 v[132:135], v17, s[8:11], s96 offen offset:1024 nt
    s_waitcnt vmcnt(2)
    buffer_load_dwordx4 v[136:139], v17, s[8:11], s96 offen offset:2048 nt
    s_waitcnt vmcnt(2)
    buffer_load_dwordx4 v[140:143], v17, s[8:11], s96 offen offset:3072 nt
    s_cmp_ge_u32 s18, 3
    s_cbranch_scc1 L_w1
    s_call_b64 s[16:17], L_qstep
L_w1:
    s_waitcnt vmcnt(2)
    buffer_load_dwordx4 v[144:147], v17, s[8:11], s97 offen nt
    s_waitcnt vmcnt(2)
    buffer_load_dwordx4 v[148:151], v17, s[8:11], s97 offen offset:1024 nt
    s_waitcnt vmcnt(2)
    buffer_load_dwordx4 v[152:155], v17, s[8:11], s97 offen offset:2048 nt
    s_waitcnt vmcnt(2)
    buffer_load_dwordx4 v[156:159], v17, s[8:11], s97 offen offset:3072 nt
    s_cmp_ge_u32 s18, 3
    s_cbranch_scc1 L_w2
    s_call_b64 s[16:17], L_qstep
L_w2:
    s_waitcnt vmcnt(2)
    buffer_load_dwordx4 v[160:163], v17, s[8:11], s98 offen nt
    s_waitcnt vmcnt(2)
    buffer_load_dwordx4 v[164:167], v17, s[8:11], s98 offen offset:1024 nt
    s_waitcnt vmcnt(2)
    buffer_load_dwordx4 v[168:171], v17, s[8:11], s98 offen offset:2048 nt
    s_waitcnt vmcnt(2)
    buffer_load_dwordx4 v[172:175], v17, s[8:11], s98 offen offset:3072 nt
    s_cmp_ge_u32 s18, 3
    s_cbranch_scc1 L_w3
    s_call_b64 s[16:17], L_qstep
L_w3:
    s_waitcnt vmcnt(2)
    buffer_load_dwordx4 v[176:179], v17, s[8:11], s99 offen nt
    s_waitcnt vmcnt(2)
    buffer_load_dwordx4 v[180:183], v17, s[8:11], s99 offen offset:1024 nt
    s_waitcnt vmcnt(2)
    buffer_load_dwordx4 v[184:187], v17, s[8:11], s99 offen offset:2048 nt
    s_waitcnt vmcnt(2)
    buffer_load_dwordx4 v[188:191], v17, s[8:11], s99 offen offset:3072 nt
L_qfin:
    s_cmp_ge_u32 s18, 3
    s_cbranch_scc1 L_qf
    s_waitcnt vmcnt(0)
    s_call_b64 s[16:17], L_qstep
    s_branch L_qfin
L_qstep:
    s_nop 1
    s_cmp_eq_u32 s18, 0
    s_cbranch_scc1 L_qs0
    v_cmp_ne_u32 vcc, v105, v19
    v_cmp_ne_u32 s[100:101], v107, v19
    s_add_u32 s77, s77, 1
    s_cmp_gt_u32 s77, 400000
    s_cbranch_scc1 L_qs1
    s_or_b64 vcc, vcc, s[100:101]
    s_cbranch_scc0 L_qs1
L_qs0:
    buffer_load_dwordx4 v[104:107], v61, s[40:43], s55 offen sc1
    s_mov_b32 s18, 1
    s_setpc_b64 s[16:17]
L_qs1:
    ds_write2_b32 v60, v104, v106 offset0:0 offset1:1
    v_mov_b32 v62, 1
    s_waitcnt lgkmcnt(0)
    s_mov_b64 exec, 1
    ds_add_u32 v3, v62 offset:5252
    s_mov_b64 exec, -1
    s_mov_b32 s18, 3
    s_setpc_b64 s[16:17]
L_qf:
    ds_read_b32 v62, v3 offset:5252
    s_waitcnt lgkmcnt(0)
    v_readfirstlane_b32 s61, v62
    s_nop 0
    s_cmp_lt_u32 s61, 8
    s_cbranch_scc1 L_qf
    v_lshlrev_b32 v62, 5, v6
    ds_read_b128 v[104:107], v62 offset:0
    ds_read_b128 v[108:111], v62 offset:16
    ds_read_b128 v[112:115], v62 offset:512
    ds_read_b128 v[116:119], v62 offset:528
    ds_read_b128 v[80:83], v62 offset:1024
    ds_read_b128 v[84:87], v62 offset:1040
    ds_read_b128 v[88:91], v62 offset:1536
    ds_read_b128 v[92:95], v62 offset:1552
    ds_read_b128 v[40:43], v62 offset:2048
    ds_read_b128 v[44:47], v62 offset:2064
    ds_read_b128 v[48:51], v62 offset:2560
    ds_read_b128 v[52:55], v62 offset:2576
    ds_read_b128 v[68:71], v62 offset:3072
    ds_read_b128 v[72:75], v62 offset:3088
    s_waitcnt lgkmcnt(10)
    v_add_f32 v104, v104, v112
    v_add_f32 v105, v105, v113
    v_add_f32 v106, v106, v114
    v_add_f32 v107, v107, v115
    v_add_f32 v108, v108, v116
    v_add_f32 v109, v109, v117
    v_add_f32 v110, v110, v118
    v_add_f32 v111, v111, v119
    ds_read_b128 v[112:115], v62 offset:3584
    ds_read_b128 v[116:119], v62 offset:3600
    s_waitcnt lgkmcnt(10)
    v_add_f32 v104, v104, v80
    v_add_f32 v105, v105, v81
    v_add_f32 v106, v106, v82
    v_add_f32 v107, v107, v83
    v_add_f32 v108, v108, v84
    v_add_f32 v109, v109, v85
    v_add_f32 v110, v110, v86
    v_add_f32 v111, v111, v87
    s_waitcnt lgkmcnt(8)
    v_add_f32 v104, v104, v88
    v_add_f32 v105, v105, v89
    v_add_f32 v106, v106, v90
    v_add_f32 v107, v107, v91
    v_add_f32 v108, v108, v92
    v_add_f32 v109, v109, v93
    v_add_f32 v110, v110, v94
    v_add_f32 v111, v111, v95
    s_waitcnt lgkmcnt(6)
    v_add_f32 v104, v104, v40
    v_add_f32 v105, v105, v41
    v_add_f32 v106, v106, v42
    v_add_f32 v107, v107, v43
    v_add_f32 v108, v108, v44
    v_add_f32 v109, v109, v45
    v_add_f32 v110, v110, v46
    v_add_f32 v111, v111, v47
    s_waitcnt lgkmcnt(4)
    v_add_f32 v104, v104, v48
    v_add_f32 v105, v105, v49
    v_add_f32 v106, v106, v50
    v_add_f32 v107, v107, v51
    v_add_f32 v108, v108, v52
    v_add_f32 v109, v109, v53
    v_add_f32 v110, v110, v54
    v_add_f32 v111, v111, v55
    s_waitcnt lgkmcnt(2)
    v_add_f32 v104, v104, v68
    v_add_f32 v105, v105, v69
    v_add_f32 v106, v106, v70
    v_add_f32 v107, v107, v71
    v_add_f32 v108, v108, v72
    v_add_f32 v109, v109, v73
    v_add_f32 v110, v110, v74
    v_add_f32 v111, v111, v75
    s_waitcnt lgkmcnt(0)
    v_add_f32 v104, v104, v112
    v_add_f32 v105, v105, v113
    v_add_f32 v106, v106, v114
    v_add_f32 v107, v107, v115
    v_add_f32 v108, v108, v116
    v_add_f32 v109, v109, v117
    v_add_f32 v110, v110, v118
    v_add_f32 v111, v111, v119
    v_cvt_pk_bf16_f32 v12, v104, v105
    v_cvt_pk_bf16_f32 v13, v106, v107
    v_cvt_pk_bf16_f32 v14, v108, v109
    v_cvt_pk_bf16_f32 v15, v110, v111
    s_add_u32 s61, s64, 32
    s_add_u32 s96, s61, 0
    s_and_b32 s96, s96, 63
    s_lshl_b32 s96, s96, 15
    s_add_u32 s97, s61, 4
    s_and_b32 s97, s97, 63
    s_lshl_b32 s97, s97, 15
    s_add_u32 s98, s61, 8
    s_and_b32 s98, s98, 63
    s_lshl_b32 s98, s98, 15
    s_add_u32 s99, s61, 12
    s_and_b32 s99, s99, 63
    s_lshl_b32 s99, s99, 15
    v_lshrrev_b32 v61, 5, v1
    v_mul_u32_u24 v61, 180224, v61
    v_and_b32 v89, 7, v1
    v_lshl_add_u32 v61, v89, 11, v61
    v_bfe_u32 v89, v1, 4, 1
    v_lshl_add_u32 v61, v89, 9, v61
    v_bfe_u32 v89, v1, 3, 1
    v_lshl_add_u32 v61, v89, 4, v61
    s_lshr_b32 s66, s60, 4
    s_lshl_b32 s66, s66, 14
    s_and_b32 s62, s60, 15
    s_lshl_b32 s62, s62, 5
    s_add_u32 s66, s66, s62
    s_add_u32 s66, s66, 0x380000
    s_cmp_ge_u32 s78, 4
    s_cbranch_scc1 L_w4
    buffer_load_dwordx4 v[76:79], v4, s[28:31], s59 offen nt
    s_add_u32 s59, s59, 4096
    buffer_load_dwordx4 v[80:83], v4, s[28:31], s59 offen nt
L_w4:
    s_waitcnt vmcnt(15)
    v_dot2_f32_bf16 v40, v192, v12, 0
    v_dot2_f32_bf16 v40, v193, v13, v40
    v_dot2_f32_bf16 v40, v194, v14, v40
    v_dot2_f32_bf16 v40, v195, v15, v40
    s_waitcnt vmcnt(2)
    buffer_load_dwordx4 v[192:195], v17, s[8:11], s96 offen nt
    s_waitcnt vmcnt(15)
    v_dot2_f32_bf16 v41, v196, v12, 0
    v_dot2_f32_bf16 v41, v197, v13, v41
    v_dot2_f32_bf16 v41, v198, v14, v41
    v_dot2_f32_bf16 v41, v199, v15, v41
    s_waitcnt vmcnt(2)
    buffer_load_dwordx4 v[196:199], v17, s[8:11], s96 offen offset:1024 nt
    s_waitcnt vmcnt(15)
    v_dot2_f32_bf16 v42, v200, v12, 0
    v_dot2_f32_bf16 v42, v201, v13, v42
    v_dot2_f32_bf16 v42, v202, v14, v42
    v_dot2_f32_bf16 v42, v203, v15, v42
    s_waitcnt vmcnt(2)
    buffer_load_dwordx4 v[200:203], v17, s[8:11], s96 offen offset:2048 nt
    s_waitcnt vmcnt(15)
    v_dot2_f32_bf16 v43, v204, v12, 0
    v_dot2_f32_bf16 v43, v205, v13, v43
    v_dot2_f32_bf16 v43, v206, v14, v43
    v_dot2_f32_bf16 v43, v207, v15, v43
    s_waitcnt vmcnt(2)
    buffer_load_dwordx4 v[204:207], v17, s[8:11], s96 offen offset:3072 nt
    s_waitcnt vmcnt(15)
    v_dot2_f32_bf16 v44, v208, v12, 0
    v_dot2_f32_bf16 v44, v209, v13, v44
    v_dot2_f32_bf16 v44, v210, v14, v44
    v_dot2_f32_bf16 v44, v211, v15, v44
    s_waitcnt vmcnt(2)
    buffer_load_dwordx4 v[208:211], v17, s[8:11], s97 offen nt
    s_waitcnt vmcnt(15)
    v_dot2_f32_bf16 v45, v212, v12, 0
    v_dot2_f32_bf16 v45, v213, v13, v45
    v_dot2_f32_bf16 v45, v214, v14, v45
    v_dot2_f32_bf16 v45, v215, v15, v45
    s_waitcnt vmcnt(2)
    buffer_load_dwordx4 v[212:215], v17, s[8:11], s97 offen offset:1024 nt
    s_waitcnt vmcnt(15)
    v_dot2_f32_bf16 v46, v216, v12, 0
    v_dot2_f32_bf16 v46, v217, v13, v46
    v_dot2_f32_bf16 v46, v218, v14, v46
    v_dot2_f32_bf16 v46, v219, v15, v46
    s_waitcnt vmcnt(2)
    buffer_load_dwordx4 v[216:219], v17, s[8:11], s97 offen offset:2048 nt
    s_waitcnt vmcnt(15)
    v_dot2_f32_bf16 v47, v220, v12, 0
    v_dot2_f32_bf16 v47, v221, v13, v47
    v_dot2_f32_bf16 v47, v222, v14, v47
    v_dot2_f32_bf16 v47, v223, v15, v47
    s_waitcnt vmcnt(2)
    buffer_load_dwordx4 v[220:223], v17, s[8:11], s97 offen offset:3072 nt
    s_waitcnt vmcnt(15)
    v_dot2_f32_bf16 v48, v224, v12, 0
    v_dot2_f32_bf16 v48, v225, v13, v48
    v_dot2_f32_bf16 v48, v226, v14, v48
    v_dot2_f32_bf16 v48, v227, v15, v48
    s_waitcnt vmcnt(2)
    buffer_load_dwordx4 v[224:227], v17, s[8:11], s98 offen nt
    s_waitcnt vmcnt(15)
    v_dot2_f32_bf16 v49, v228, v12, 0
    v_dot2_f32_bf16 v49, v229, v13, v49
    v_dot2_f32_bf16 v49, v230, v14, v49
    v_dot2_f32_bf16 v49, v231, v15, v49
    s_waitcnt vmcnt(2)
    buffer_load_dwordx4 v[228:231], v17, s[8:11], s98 offen offset:1024 nt
    s_waitcnt vmcnt(15)
    v_dot2_f32_bf16 v50, v232, v12, 0
    v_dot2_f32_bf16 v50, v233, v13, v50
    v_dot2_f32_bf16 v50, v234, v14, v50
    v_dot2_f32_bf16 v50, v235, v15, v50
    s_waitcnt vmcnt(2)
    buffer_load_dwordx4 v[232:235], v17, s[8:11], s98 offen offset:2048 nt
    s_waitcnt vmcnt(15)
    v_dot2_f32_bf16 v51, v236, v12, 0
    v_dot2_f32_bf16 v51, v237, v13, v51
    v_dot2_f32_bf16 v51, v238, v14, v51
    v_dot2_f32_bf16 v51, v239, v15, v51
    s_waitcnt vmcnt(2)
    buffer_load_dwordx4 v[236:239], v17, s[8:11], s98 offen offset:3072 nt
    s_waitcnt vmcnt(15)
    v_dot2_f32_bf16 v52, v240, v12, 0
    v_dot2_f32_bf16 v52, v241, v13, v52
    v_dot2_f32_bf16 v52, v242, v14, v52
    v_dot2_f32_bf16 v52, v243, v15, v52
    s_waitcnt vmcnt(2)
    buffer_load_dwordx4 v[240:243], v17, s[8:11], s99 offen nt
    s_waitcnt vmcnt(15)
    v_dot2_f32_bf16 v53, v244, v12, 0
    v_dot2_f32_bf16 v53, v245, v13, v53
    v_dot2_f32_bf16 v53, v246, v14, v53
    v_dot2_f32_bf16 v53, v247, v15, v53
    s_waitcnt vmcnt(2)
    buffer_load_dwordx4 v[244:247], v17, s[8:11], s99 offen offset:1024 nt
    s_waitcnt vmcnt(15)
    v_dot2_f32_bf16 v54, v248, v12, 0
    v_dot2_f32_bf16 v54, v249, v13, v54
    v_dot2_f32_bf16 v54, v250, v14, v54
    v_dot2_f32_bf16 v54, v251, v15, v54
    s_waitcnt vmcnt(2)
    buffer_load_dwordx4 v[248:251], v17, s[8:11], s99 offen offset:2048 nt
    s_waitcnt vmcnt(15)
    v_dot2_f32_bf16 v55, v252, v12, 0
    v_dot2_f32_bf16 v55, v253, v13, v55
    v_dot2_f32_bf16 v55, v254, v14, v55
    v_dot2_f32_bf16 v55, v255, v15, v55
    s_waitcnt vmcnt(2)
    buffer_load_dwordx4 v[252:255], v17, s[8:11], s99 offen offset:3072 nt
    s_add_u32 s61, s64, 48
    s_add_u32 s96, s61, 0
    s_and_b32 s96, s96, 63
    s_lshl_b32 s96, s96, 15
    s_add_u32 s97, s61, 4
    s_and_b32 s97, s97, 63
    s_lshl_b32 s97, s97, 15
    s_add_u32 s98, s61, 8
    s_and_b32 s98, s98, 63
    s_lshl_b32 s98, s98, 15
    s_add_u32 s99, s61, 12
    s_and_b32 s99, s99, 63
    s_lshl_b32 s99, s99, 15
    s_waitcnt vmcnt(15)
    v_dot2_f32_bf16 v104, v128, v12, 0
    v_dot2_f32_bf16 v104, v129, v13, v104
    v_dot2_f32_bf16 v104, v130, v14, v104
    v_dot2_f32_bf16 v104, v131, v15, v104
    s_waitcnt vmcnt(2)
    buffer_load_dwordx4 v[128:131], v17, s[8:11], s96 offen nt
    s_waitcnt vmcnt(15)
    v_dot2_f32_bf16 v105, v132, v12, 0
    v_dot2_f32_bf16 v105, v133, v13, v105
    v_dot2_f32_bf16 v105, v134, v14, v105
    v_dot2_f32_bf16 v105, v135, v15, v105
    s_waitcnt vmcnt(2)
    buffer_load_dwordx4 v[132:135], v17, s[8:11], s96 offen offset:1024 nt
    v_add_f32_dpp v40, v40, v40 row_ror:8 row_mask:0xf bank_mask:0x3
    v_add_f32_dpp v41, v41, v41 row_ror:8 row_mask:0xf bank_mask:0x3
    v_add_f32_dpp v42, v42, v42 row_ror:8 row_mask:0xf bank_mask:0x3
    v_add_f32_dpp v43, v43, v43 row_ror:8 row_mask:0xf bank_mask:0x3
    v_add_f32_dpp v44, v44, v44 row_ror:8 row_mask:0xf bank_mask:0x3
    v_add_f32_dpp v45, v45, v45 row_ror:8 row_mask:0xf bank_mask:0x3
    v_add_f32_dpp v46, v46, v46 row_ror:8 row_mask:0xf bank_mask:0x3
    v_add_f32_dpp v47, v47, v47 row_ror:8 row_mask:0xf bank_mask:0x3
    v_add_f32_dpp v40, v48, v48 row_ror:8 row_mask:0xf bank_mask:0xc
    v_add_f32_dpp v41, v49, v49 row_ror:8 row_mask:0xf bank_mask:0xc
    v_add_f32_dpp v42, v50, v50 row_ror:8 row_mask:0xf bank_mask:0xc
    v_add_f32_dpp v43, v51, v51 row_ror:8 row_mask:0xf bank_mask:0xc
    v_add_f32_dpp v44, v52, v52 row_ror:8 row_mask:0xf bank_mask:0xc
    v_add_f32_dpp v45, v53, v53 row_ror:8 row_mask:0xf bank_mask:0xc
    v_add_f32_dpp v46, v54, v54 row_ror:8 row_mask:0xf bank_mask:0xc
    v_add_f32_dpp v47, v55, v55 row_ror:8 row_mask:0xf bank_mask:0xc
    v_add_f32_dpp v40, v40, v40 row_half_mirror row_mask:0xf bank_mask:0x5
    v_add_f32_dpp v41, v41, v41 row_half_mirror row_mask:0xf bank_mask:0x5
    v_add_f32_dpp v42, v42, v42 row_half_mirror row_mask:0xf bank_mask:0x5
    v_add_f32_dpp v43, v43, v43 row_half_mirror row_mask:0xf bank_mask:0x5
    v_add_f32_dpp v40, v44, v44 row_half_mirror row_mask:0xf bank_mask:0xa
    v_add_f32_dpp v41, v45, v45 row_half_mirror row_mask:0xf bank_mask:0xa
    v_add_f32_dpp v42, v46, v46 row_half_mirror row_mask:0xf bank_mask:0xa
    v_add_f32_dpp v43, v47, v47 row_half_mirror row_mask:0xf bank_mask:0xa
    v_add_f32_dpp v40, v40, v40 quad_perm:[1,0,3,2] row_mask:0xf bank_mask:0xf
    v_add_f32_dpp v41, v41, v41 quad_perm:[1,0,3,2] row_mask:0xf bank_mask:0xf
    v_add_f32_dpp v42, v42, v42 quad_perm:[1,0,3,2] row_mask:0xf bank_mask:0xf
    v_add_f32_dpp v43, v43, v43 quad_perm:[1,0,3,2] row_mask:0xf bank_mask:0xf
    v_cndmask_b32 v40, v40, v41, s[44:45]
    v_cndmask_b32 v42, v42, v43, s[44:45]
    s_nop 0
    v_add_f32_dpp v40, v40, v40 quad_perm:[2,3,0,1] row_mask:0xf bank_mask:0xf
    v_add_f32_dpp v42, v42, v42 quad_perm:[2,3,0,1] row_mask:0xf bank_mask:0xf
    v_cndmask_b32 v16, v40, v42, s[46:47]
    v_cvt_pk_bf16_f32 v16, v16, v16
    v_lshlrev_b32 v16, 16, v16
    v_mul_f32 v16, s73, v16
    v_cvt_pk_bf16_f32 v16, v16, v16
    v_lshlrev_b32 v56, 16, v16
    s_waitcnt vmcnt(15)
    v_dot2_f32_bf16 v106, v136, v12, 0
    v_dot2_f32_bf16 v106, v137, v13, v106
    v_dot2_f32_bf16 v106, v138, v14, v106
    v_dot2_f32_bf16 v106, v139, v15, v106
    s_waitcnt vmcnt(2)
    buffer_load_dwordx4 v[136:139], v17, s[8:11], s96 offen offset:2048 nt
    s_waitcnt vmcnt(15)
    v_dot2_f32_bf16 v107, v140, v12, 0
    v_dot2_f32_bf16 v107, v141, v13, v107
    v_dot2_f32_bf16 v107, v142, v14, v107
    v_dot2_f32_bf16 v107, v143, v15, v107
    s_waitcnt vmcnt(2)
    buffer_load_dwordx4 v[140:143], v17, s[8:11], s96 offen offset:3072 nt
    s_waitcnt vmcnt(15)
    v_dot2_f32_bf16 v108, v144, v12, 0
    v_dot2_f32_bf16 v108, v145, v13, v108
    v_dot2_f32_bf16 v108, v146, v14, v108
    v_dot2_f32_bf16 v108, v147, v15, v108
    s_waitcnt vmcnt(2)
    buffer_load_dwordx4 v[144:147], v17, s[8:11], s97 offen nt
    s_cmp_ge_u32 s78, 4
    s_cbranch_scc1 L_w5
    buffer_load_dwordx4 v[68:71], v61, s[40:43], s66 offen sc1
    buffer_load_dwordx4 v[72:75], v61, s[40:43], s66 offen offset:1024 sc1
L_w5:
    s_waitcnt vmcnt(15)
    v_dot2_f32_bf16 v109, v148, v12, 0
    v_dot2_f32_bf16 v109, v149, v13, v109
    v_dot2_f32_bf16 v109, v150, v14, v109
    v_dot2_f32_bf16 v109, v151, v15, v109
    s_waitcnt vmcnt(2)
    buffer_load_dwordx4 v[148:151], v17, s[8:11], s97 offen offset:1024 nt
    s_waitcnt vmcnt(15)
    v_dot2_f32_bf16 v110, v152, v12, 0
    v_dot2_f32_bf16 v110, v153, v13, v110
    v_dot2_f32_bf16 v110, v154, v14, v110
    v_dot2_f32_bf16 v110, v155, v15, v110
    s_waitcnt vmcnt(2)
    buffer_load_dwordx4 v[152:155], v17, s[8:11], s97 offen offset:2048 nt
    s_waitcnt vmcnt(15)
    v_dot2_f32_bf16 v111, v156, v12, 0
    v_dot2_f32_bf16 v111, v157, v13, v111
    v_dot2_f32_bf16 v111, v158, v14, v111
    v_dot2_f32_bf16 v111, v159, v15, v111
    s_waitcnt vmcnt(2)
    buffer_load_dwordx4 v[156:159], v17, s[8:11], s97 offen offset:3072 nt
    s_waitcnt vmcnt(15)
    v_dot2_f32_bf16 v112, v160, v12, 0
    v_dot2_f32_bf16 v112, v161, v13, v112
    v_dot2_f32_bf16 v112, v162, v14, v112
    v_dot2_f32_bf16 v112, v163, v15, v112
    s_waitcnt vmcnt(2)
    buffer_load_dwordx4 v[160:163], v17, s[8:11], s98 offen nt
    s_waitcnt vmcnt(15)
    v_dot2_f32_bf16 v113, v164, v12, 0
    v_dot2_f32_bf16 v113, v165, v13, v113
    v_dot2_f32_bf16 v113, v166, v14, v113
    v_dot2_f32_bf16 v113, v167, v15, v113
    s_waitcnt vmcnt(2)
    buffer_load_dwordx4 v[164:167], v17, s[8:11], s98 offen offset:1024 nt
    s_waitcnt vmcnt(15)
    v_dot2_f32_bf16 v114, v168, v12, 0
    v_dot2_f32_bf16 v114, v169, v13, v114
    v_dot2_f32_bf16 v114, v170, v14, v114
    v_dot2_f32_bf16 v114, v171, v15, v114
    s_waitcnt vmcnt(2)
    buffer_load_dwordx4 v[168:171], v17, s[8:11], s98 offen offset:2048 nt
    s_cmp_ge_u32 s78, 4
    s_cbranch_scc1 L_w6
    s_mov_b32 s77, 0
    s_branch L_g1
L_g0:
    buffer_load_dwordx4 v[68:71], v61, s[40:43], s66 offen sc1
    buffer_load_dwordx4 v[72:75], v61, s[40:43], s66 offen offset:1024 sc1
    s_waitcnt vmcnt(0)
L_g1:
    v_xor_b32 v84, v69, v19
    v_xor_b32 v85, v71, v19
    v_xor_b32 v86, v73, v19
    v_xor_b32 v87, v75, v19
    v_or3_b32 v84, v84, v85, v86
    v_or_b32 v84, v84, v87
    v_cmp_ne_u32 vcc, 0, v84
    s_add_u32 s77, s77, 1
    s_cmp_gt_u32 s77, 400000
    s_cbranch_scc1 L_g2
    s_cmp_lg_u64 vcc, 0
    s_cbranch_scc1 L_g0
L_g2:
    v_mov_b32 v84, v68
    v_mov_b32 v85, v70
    v_mov_b32 v86, v72
    v_mov_b32 v87, v74
    v_add_f32_dpp v84, v84, v84 quad_perm:[1,0,3,2] row_mask:0xf bank_mask:0xf
    v_add_f32_dpp v85, v85, v85 quad_perm:[1,0,3,2] row_mask:0xf bank_mask:0xf
    v_add_f32_dpp v86, v86, v86 quad_perm:[1,0,3,2] row_mask:0xf bank_mask:0xf
    v_add_f32_dpp v87, v87, v87 quad_perm:[1,0,3,2] row_mask:0xf bank_mask:0xf
    v_add_f32_dpp v84, v84, v84 quad_perm:[2,3,0,1] row_mask:0xf bank_mask:0xf
    v_add_f32_dpp v85, v85, v85 quad_perm:[2,3,0,1] row_mask:0xf bank_mask:0xf
    v_add_f32_dpp v86, v86, v86 quad_perm:[2,3,0,1] row_mask:0xf bank_mask:0xf
    v_add_f32_dpp v87, v87, v87 quad_perm:[2,3,0,1] row_mask:0xf bank_mask:0xf
    v_add_f32_dpp v84, v84, v84 row_half_mirror row_mask:0xf bank_mask:0xf
    v_add_f32_dpp v85, v85, v85 row_half_mirror row_mask:0xf bank_mask:0xf
    v_add_f32_dpp v86, v86, v86 row_half_mirror row_mask:0xf bank_mask:0xf
    v_add_f32_dpp v87, v87, v87 row_half_mirror row_mask:0xf bank_mask:0xf
    s_lshl_b32 s61, s54, 7
    v_lshrrev_b32 v88, 3, v1
    v_lshl_add_u32 v88, v88, 4, s61
    ds_write_b128 v88, v[84:87] offset:4096
    v_and_b32 v89, 1, v6
    v_lshl_add_u32 v89, v89, 2, v5
    v_lshl_add_u32 v89, v89, 2, s61
    s_waitcnt lgkmcnt(0)
    ds_read_b32 v92, v89 offset:4096
    ds_read_b32 v93, v89 offset:4128
    ds_read_b32 v94, v89 offset:4160
    ds_read_b32 v95, v89 offset:4192
    s_waitcnt lgkmcnt(0)
    v_cvt_pk_bf16_f32 v100, v92, v93
    v_cvt_pk_bf16_f32 v101, v94, v95
    v_lshlrev_b32 v96, 16, v100
    v_and_b32 v97, s74, v100
    v_lshlrev_b32 v98, 16, v101
    v_and_b32 v99, s74, v101
    v_mul_f32 v92, v96, v96
    v_mul_f32 v93, v97, v97
    v_mul_f32 v92, v92, v96
    v_mul_f32 v93, v93, v97
    s_mov_b32 s61, 0x3d372713
    v_fma_f32 v92, v92, s61, v96
    v_fma_f32 v93, v93, s61, v97
    v_mul_f32 v92, 0xc0135761, v92
    v_mul_f32 v93, 0xc0135761, v93
    v_exp_f32 v92, v92
    v_exp_f32 v93, v93
    v_add_f32 v92, 1.0, v92
    v_add_f32 v93, 1.0, v93
    v_rcp_f32 v92, v92
    v_rcp_f32 v93, v93
    v_mul_f32 v92, v92, v96
    v_mul_f32 v93, v93, v97
    v_cvt_pk_bf16_f32 v100, v92, v93
    v_lshlrev_b32 v92, 16, v100
    v_and_b32 v93, s74, v100
    v_mul_f32 v92, v92, v98
    v_mul_f32 v93, v93, v99
    v_cvt_pk_bf16_f32 v94, v92, v93
    s_nop 1
    v_mov_b32_dpp v32, v94 row_newbcast:0 row_mask:0xf bank_mask:0xf
    v_perm_b32 v24, v32, v32, v8
    v_perm_b32 v25, v32, v32, v9
    v_perm_b32 v26, v32, v32, v10
    v_perm_b32 v27, v32, v32, v11
    v_mov_b32_dpp v33, v94 row_newbcast:1 row_mask:0xf bank_mask:0xf
    v_perm_b32 v28, v33, v33, v8
    v_perm_b32 v29, v33, v33, v9
    v_perm_b32 v30, v33, v33, v10
    v_perm_b32 v31, v33, v33, v11
    v_mfma_f32_16x16x32_bf16 v[84:87], v[24:27], v[76:79], 0
    s_nop 0
    v_mfma_f32_16x16x32_bf16 v[84:87], v[28:31], v[80:83], v[84:87]
    s_nop 7
    buffer_store_dwordx4 v[84:87], v36, s[40:43], 0 offen sc1
L_w6:
    s_waitcnt vmcnt(15)
    v_dot2_f32_bf16 v115, v172, v12, 0
    v_dot2_f32_bf16 v115, v173, v13, v115
    v_dot2_f32_bf16 v115, v174, v14, v115
    v_dot2_f32_bf16 v115, v175, v15, v115
    s_waitcnt vmcnt(2)
    buffer_load_dwordx4 v[172:175], v17, s[8:11], s98 offen offset:3072 nt
    s_waitcnt vmcnt(15)
    v_dot2_f32_bf16 v116, v176, v12, 0
    v_dot2_f32_bf16 v116, v177, v13, v116
    v_dot2_f32_bf16 v116, v178, v14, v116
    v_dot2_f32_bf16 v116, v179, v15, v116
    s_waitcnt vmcnt(2)
    buffer_load_dwordx4 v[176:179], v17, s[8:11], s99 offen nt
    s_waitcnt vmcnt(15)
    v_dot2_f32_bf16 v117, v180, v12, 0
    v_dot2_f32_bf16 v117, v181, v13, v117
    v_dot2_f32_bf16 v117, v182, v14, v117
    v_dot2_f32_bf16 v117, v183, v15, v117
    s_waitcnt vmcnt(2)
    buffer_load_dwordx4 v[180:183], v17, s[8:11], s99 offen offset:1024 nt
    s_waitcnt vmcnt(15)
    v_dot2_f32_bf16 v118, v184, v12, 0
    v_dot2_f32_bf16 v118, v185, v13, v118
    v_dot2_f32_bf16 v118, v186, v14, v118
    v_dot2_f32_bf16 v118, v187, v15, v118
    s_waitcnt vmcnt(2)
    buffer_load_dwordx4 v[184:187], v17, s[8:11], s99 offen offset:2048 nt
    s_waitcnt vmcnt(15)
    v_dot2_f32_bf16 v119, v188, v12, 0
    v_dot2_f32_bf16 v119, v189, v13, v119
    v_dot2_f32_bf16 v119, v190, v14, v119
    v_dot2_f32_bf16 v119, v191, v15, v119
    s_waitcnt vmcnt(2)
    buffer_load_dwordx4 v[188:191], v17, s[8:11], s99 offen offset:3072 nt
    s_mov_b32 s8, s12
    s_mov_b32 s9, s13
    s_add_u32 s61, s64, 0
    s_add_u32 s96, s61, 0
    s_and_b32 s96, s96, 63
    s_lshl_b32 s96, s96, 15
    s_add_u32 s97, s61, 4
    s_and_b32 s97, s97, 63
    s_lshl_b32 s97, s97, 15
    s_add_u32 s98, s61, 8
    s_and_b32 s98, s98, 63
    s_lshl_b32 s98, s98, 15
    s_add_u32 s99, s61, 12
    s_and_b32 s99, s99, 63
    s_lshl_b32 s99, s99, 15
    s_waitcnt vmcnt(15)
    v_dot2_f32_bf16 v40, v192, v12, 0
    v_dot2_f32_bf16 v40, v193, v13, v40
    v_dot2_f32_bf16 v40, v194, v14, v40
    v_dot2_f32_bf16 v40, v195, v15, v40
    s_waitcnt vmcnt(2)
    buffer_load_dwordx4 v[192:195], v17, s[8:11], s96 offen nt
    s_waitcnt vmcnt(15)
    v_dot2_f32_bf16 v41, v196, v12, 0
    v_dot2_f32_bf16 v41, v197, v13, v41
    v_dot2_f32_bf16 v41, v198, v14, v41
    v_dot2_f32_bf16 v41, v199, v15, v41
    s_waitcnt vmcnt(2)
    buffer_load_dwordx4 v[196:199], v17, s[8:11], s96 offen offset:1024 nt
    v_add_f32_dpp v104, v104, v104 row_ror:8 row_mask:0xf bank_mask:0x3
    v_add_f32_dpp v105, v105, v105 row_ror:8 row_mask:0xf bank_mask:0x3
    v_add_f32_dpp v106, v106, v106 row_ror:8 row_mask:0xf bank_mask:0x3
    v_add_f32_dpp v107, v107, v107 row_ror:8 row_mask:0xf bank_mask:0x3
    v_add_f32_dpp v108, v108, v108 row_ror:8 row_mask:0xf bank_mask:0x3
    v_add_f32_dpp v109, v109, v109 row_ror:8 row_mask:0xf bank_mask:0x3
    v_add_f32_dpp v110, v110, v110 row_ror:8 row_mask:0xf bank_mask:0x3
    v_add_f32_dpp v111, v111, v111 row_ror:8 row_mask:0xf bank_mask:0x3
    v_add_f32_dpp v104, v112, v112 row_ror:8 row_mask:0xf bank_mask:0xc
    v_add_f32_dpp v105, v113, v113 row_ror:8 row_mask:0xf bank_mask:0xc
    v_add_f32_dpp v106, v114, v114 row_ror:8 row_mask:0xf bank_mask:0xc
    v_add_f32_dpp v107, v115, v115 row_ror:8 row_mask:0xf bank_mask:0xc
    v_add_f32_dpp v108, v116, v116 row_ror:8 row_mask:0xf bank_mask:0xc
    v_add_f32_dpp v109, v117, v117 row_ror:8 row_mask:0xf bank_mask:0xc
    v_add_f32_dpp v110, v118, v118 row_ror:8 row_mask:0xf bank_mask:0xc
    v_add_f32_dpp v111, v119, v119 row_ror:8 row_mask:0xf bank_mask:0xc
    v_add_f32_dpp v104, v104, v104 row_half_mirror row_mask:0xf bank_mask:0x5
    v_add_f32_dpp v105, v105, v105 row_half_mirror row_mask:0xf bank_mask:0x5
    v_add_f32_dpp v106, v106, v106 row_half_mirror row_mask:0xf bank_mask:0x5
    v_add_f32_dpp v107, v107, v107 row_half_mirror row_mask:0xf bank_mask:0x5
    v_add_f32_dpp v104, v108, v108 row_half_mirror row_mask:0xf bank_mask:0xa
    v_add_f32_dpp v105, v109, v109 row_half_mirror row_mask:0xf bank_mask:0xa
    v_add_f32_dpp v106, v110, v110 row_half_mirror row_mask:0xf bank_mask:0xa
    v_add_f32_dpp v107, v111, v111 row_half_mirror row_mask:0xf bank_mask:0xa
    v_add_f32_dpp v104, v104, v104 quad_perm:[1,0,3,2] row_mask:0xf bank_mask:0xf
    v_add_f32_dpp v105, v105, v105 quad_perm:[1,0,3,2] row_mask:0xf bank_mask:0xf
    v_add_f32_dpp v106, v106, v106 quad_perm:[1,0,3,2] row_mask:0xf bank_mask:0xf
    v_add_f32_dpp v107, v107, v107 quad_perm:[1,0,3,2] row_mask:0xf bank_mask:0xf
    v_cndmask_b32 v104, v104, v105, s[44:45]
    v_cndmask_b32 v106, v106, v107, s[44:45]
    s_nop 0
    v_add_f32_dpp v104, v104, v104 quad_perm:[2,3,0,1] row_mask:0xf bank_mask:0xf
    v_add_f32_dpp v106, v106, v106 quad_perm:[2,3,0,1] row_mask:0xf bank_mask:0xf
    v_cndmask_b32 v16, v104, v106, s[46:47]
    v_cvt_pk_bf16_f32 v16, v16, v16
    v_lshlrev_b32 v16, 16, v16
    v_mul_f32 v16, s73, v16
    v_cvt_pk_bf16_f32 v16, v16, v16
    v_lshlrev_b32 v57, 16, v16
    s_waitcnt vmcnt(15)
    v_dot2_f32_bf16 v42, v200, v12, 0
    v_dot2_f32_bf16 v42, v201, v13, v42
    v_dot2_f32_bf16 v42, v202, v14, v42
    v_dot2_f32_bf16 v42, v203, v15, v42
    s_waitcnt vmcnt(2)
    buffer_load_dwordx4 v[200:203], v17, s[8:11], s96 offen offset:2048 nt
    s_waitcnt vmcnt(15)
    v_dot2_f32_bf16 v43, v204, v12, 0
    v_dot2_f32_bf16 v43, v205, v13, v43
    v_dot2_f32_bf16 v43, v206, v14, v43
    v_dot2_f32_bf16 v43, v207, v15, v43
    s_waitcnt vmcnt(2)
    buffer_load_dwordx4 v[204:207], v17, s[8:11], s96 offen offset:3072 nt
    s_waitcnt vmcnt(15)
    v_dot2_f32_bf16 v44, v208, v12, 0
    v_dot2_f32_bf16 v44, v209, v13, v44
    v_dot2_f32_bf16 v44, v210, v14, v44
    v_dot2_f32_bf16 v44, v211, v15, v44
    s_waitcnt vmcnt(2)
    buffer_load_dwordx4 v[208:211], v17, s[8:11], s97 offen nt
    v_dot2_f32_bf16 v104, v128, v12, 0
    v_dot2_f32_bf16 v104, v129, v13, v104
    v_dot2_f32_bf16 v104, v130, v14, v104
    v_dot2_f32_bf16 v104, v131, v15, v104
    v_dot2_f32_bf16 v105, v132, v12, 0
    v_dot2_f32_bf16 v105, v133, v13, v105
    v_dot2_f32_bf16 v105, v134, v14, v105
    v_dot2_f32_bf16 v105, v135, v15, v105
    s_waitcnt vmcnt(15)
    v_dot2_f32_bf16 v45, v212, v12, 0
    v_dot2_f32_bf16 v45, v213, v13, v45
    v_dot2_f32_bf16 v45, v214, v14, v45
    v_dot2_f32_bf16 v45, v215, v15, v45
    s_waitcnt vmcnt(2)
    buffer_load_dwordx4 v[212:215], v17, s[8:11], s97 offen offset:1024 nt
    v_dot2_f32_bf16 v106, v136, v12, 0
    v_dot2_f32_bf16 v106, v137, v13, v106
    v_dot2_f32_bf16 v106, v138, v14, v106
    v_dot2_f32_bf16 v106, v139, v15, v106
    v_dot2_f32_bf16 v107, v140, v12, 0
    v_dot2_f32_bf16 v107, v141, v13, v107
    v_dot2_f32_bf16 v107, v142, v14, v107
    v_dot2_f32_bf16 v107, v143, v15, v107
    s_waitcnt vmcnt(15)
    v_dot2_f32_bf16 v46, v216, v12, 0
    v_dot2_f32_bf16 v46, v217, v13, v46
    v_dot2_f32_bf16 v46, v218, v14, v46
    v_dot2_f32_bf16 v46, v219, v15, v46
    s_waitcnt vmcnt(2)
    buffer_load_dwordx4 v[216:219], v17, s[8:11], s97 offen offset:2048 nt
    v_dot2_f32_bf16 v108, v144, v12, 0
    v_dot2_f32_bf16 v108, v145, v13, v108
    v_dot2_f32_bf16 v108, v146, v14, v108
    v_dot2_f32_bf16 v108, v147, v15, v108
    v_dot2_f32_bf16 v109, v148, v12, 0
    v_dot2_f32_bf16 v109, v149, v13, v109
    v_dot2_f32_bf16 v109, v150, v14, v109
    v_dot2_f32_bf16 v109, v151, v15, v109
    v_mov_b32 v60, 1
    s_mov_b64 exec, 1
    ds_add_rtn_u32 v60, v3, v60 offset:5248
    s_mov_b64 exec, -1
    s_waitcnt lgkmcnt(0)
    v_readfirstlane_b32 s62, v60
    s_nop 0
    s_cmp_lg_u32 s62, 7
    s_cbranch_scc1 L_w7
    s_mov_b32 s57, 1
    s_atomic_add s57, s[36:37], 252
L_w7:
    s_waitcnt vmcnt(15)
    v_dot2_f32_bf16 v47, v220, v12, 0
    v_dot2_f32_bf16 v47, v221, v13, v47
    v_dot2_f32_bf16 v47, v222, v14, v47
    v_dot2_f32_bf16 v47, v223, v15, v47
    s_waitcnt vmcnt(2)
    buffer_load_dwordx4 v[220:223], v17, s[8:11], s97 offen offset:3072 nt
    v_dot2_f32_bf16 v110, v152, v12, 0
    v_dot2_f32_bf16 v110, v153, v13, v110
    v_dot2_f32_bf16 v110, v154, v14, v110
    v_dot2_f32_bf16 v110, v155, v15, v110
    v_dot2_f32_bf16 v111, v156, v12, 0
    v_dot2_f32_bf16 v111, v157, v13, v111
    v_dot2_f32_bf16 v111, v158, v14, v111
    v_dot2_f32_bf16 v111, v159, v15, v111
    s_waitcnt vmcnt(15)
    v_dot2_f32_bf16 v48, v224, v12, 0
    v_dot2_f32_bf16 v48, v225, v13, v48
    v_dot2_f32_bf16 v48, v226, v14, v48
    v_dot2_f32_bf16 v48, v227, v15, v48
    s_waitcnt vmcnt(2)
    buffer_load_dwordx4 v[224:227], v17, s[8:11], s98 offen nt
    v_dot2_f32_bf16 v112, v160, v12, 0
    v_dot2_f32_bf16 v112, v161, v13, v112
    v_dot2_f32_bf16 v112, v162, v14, v112
    v_dot2_f32_bf16 v112, v163, v15, v112
    v_dot2_f32_bf16 v113, v164, v12, 0
    v_dot2_f32_bf16 v113, v165, v13, v113
    v_dot2_f32_bf16 v113, v166, v14, v113
    v_dot2_f32_bf16 v113, v167, v15, v113
    s_waitcnt vmcnt(15)
    v_dot2_f32_bf16 v49, v228, v12, 0
    v_dot2_f32_bf16 v49, v229, v13, v49
    v_dot2_f32_bf16 v49, v230, v14, v49
    v_dot2_f32_bf16 v49, v231, v15, v49
    s_waitcnt vmcnt(2)
    buffer_load_dwordx4 v[228:231], v17, s[8:11], s98 offen offset:1024 nt
    v_dot2_f32_bf16 v114, v168, v12, 0
    v_dot2_f32_bf16 v114, v169, v13, v114
    v_dot2_f32_bf16 v114, v170, v14, v114
    v_dot2_f32_bf16 v114, v171, v15, v114
    v_dot2_f32_bf16 v115, v172, v12, 0
    v_dot2_f32_bf16 v115, v173, v13, v115
    v_dot2_f32_bf16 v115, v174, v14, v115
    v_dot2_f32_bf16 v115, v175, v15, v115
    s_waitcnt vmcnt(15)
    v_dot2_f32_bf16 v50, v232, v12, 0
    v_dot2_f32_bf16 v50, v233, v13, v50
    v_dot2_f32_bf16 v50, v234, v14, v50
    v_dot2_f32_bf16 v50, v235, v15, v50
    s_waitcnt vmcnt(2)
    buffer_load_dwordx4 v[232:235], v17, s[8:11], s98 offen offset:2048 nt
    v_dot2_f32_bf16 v116, v176, v12, 0
    v_dot2_f32_bf16 v116, v177, v13, v116
    v_dot2_f32_bf16 v116, v178, v14, v116
    v_dot2_f32_bf16 v116, v179, v15, v116
    v_dot2_f32_bf16 v117, v180, v12, 0
    v_dot2_f32_bf16 v117, v181, v13, v117
    v_dot2_f32_bf16 v117, v182, v14, v117
    v_dot2_f32_bf16 v117, v183, v15, v117
    s_waitcnt vmcnt(15)
    v_dot2_f32_bf16 v51, v236, v12, 0
    v_dot2_f32_bf16 v51, v237, v13, v51
    v_dot2_f32_bf16 v51, v238, v14, v51
    v_dot2_f32_bf16 v51, v239, v15, v51
    s_waitcnt vmcnt(2)
    buffer_load_dwordx4 v[236:239], v17, s[8:11], s98 offen offset:3072 nt
    v_dot2_f32_bf16 v118, v184, v12, 0
    v_dot2_f32_bf16 v118, v185, v13, v118
    v_dot2_f32_bf16 v118, v186, v14, v118
    v_dot2_f32_bf16 v118, v187, v15, v118
    v_dot2_f32_bf16 v119, v188, v12, 0
    v_dot2_f32_bf16 v119, v189, v13, v119
    v_dot2_f32_bf16 v119, v190, v14, v119
    v_dot2_f32_bf16 v119, v191, v15, v119
    s_waitcnt vmcnt(15)
    v_dot2_f32_bf16 v52, v240, v12, 0
    v_dot2_f32_bf16 v52, v241, v13, v52
    v_dot2_f32_bf16 v52, v242, v14, v52
    v_dot2_f32_bf16 v52, v243, v15, v52
    s_waitcnt vmcnt(2)
    buffer_load_dwordx4 v[240:243], v17, s[8:11], s99 offen nt
    v_add_f32_dpp v104, v104, v104 row_ror:8 row_mask:0xf bank_mask:0x3
    v_add_f32_dpp v105, v105, v105 row_ror:8 row_mask:0xf bank_mask:0x3
    v_add_f32_dpp v106, v106, v106 row_ror:8 row_mask:0xf bank_mask:0x3
    v_add_f32_dpp v107, v107, v107 row_ror:8 row_mask:0xf bank_mask:0x3
    v_add_f32_dpp v108, v108, v108 row_ror:8 row_mask:0xf bank_mask:0x3
    v_add_f32_dpp v109, v109, v109 row_ror:8 row_mask:0xf bank_mask:0x3
    v_add_f32_dpp v110, v110, v110 row_ror:8 row_mask:0xf bank_mask:0x3
    v_add_f32_dpp v111, v111, v111 row_ror:8 row_mask:0xf bank_mask:0x3
    v_add_f32_dpp v104, v112, v112 row_ror:8 row_mask:0xf bank_mask:0xc
    v_add_f32_dpp v105, v113, v113 row_ror:8 row_mask:0xf bank_mask:0xc
    v_add_f32_dpp v106, v114, v114 row_ror:8 row_mask:0xf bank_mask:0xc
    v_add_f32_dpp v107, v115, v115 row_ror:8 row_mask:0xf bank_mask:0xc
    v_add_f32_dpp v108, v116, v116 row_ror:8 row_mask:0xf bank_mask:0xc
    v_add_f32_dpp v109, v117, v117 row_ror:8 row_mask:0xf bank_mask:0xc
    v_add_f32_dpp v110, v118, v118 row_ror:8 row_mask:0xf bank_mask:0xc
    v_add_f32_dpp v111, v119, v119 row_ror:8 row_mask:0xf bank_mask:0xc
    v_add_f32_dpp v104, v104, v104 row_half_mirror row_mask:0xf bank_mask:0x5
    v_add_f32_dpp v105, v105, v105 row_half_mirror row_mask:0xf bank_mask:0x5
    v_add_f32_dpp v106, v106, v106 row_half_mirror row_mask:0xf bank_mask:0x5
    v_add_f32_dpp v107, v107, v107 row_half_mirror row_mask:0xf bank_mask:0x5
    v_add_f32_dpp v104, v108, v108 row_half_mirror row_mask:0xf bank_mask:0xa
    v_add_f32_dpp v105, v109, v109 row_half_mirror row_mask:0xf bank_mask:0xa
    v_add_f32_dpp v106, v110, v110 row_half_mirror row_mask:0xf bank_mask:0xa
    v_add_f32_dpp v107, v111, v111 row_half_mirror row_mask:0xf bank_mask:0xa
    v_add_f32_dpp v104, v104, v104 quad_perm:[1,0,3,2] row_mask:0xf bank_mask:0xf
    v_add_f32_dpp v105, v105, v105 quad_perm:[1,0,3,2] row_mask:0xf bank_mask:0xf
    v_add_f32_dpp v106, v106, v106 quad_perm:[1,0,3,2] row_mask:0xf bank_mask:0xf
    v_add_f32_dpp v107, v107, v107 quad_perm:[1,0,3,2] row_mask:0xf bank_mask:0xf
    v_cndmask_b32 v104, v104, v105, s[44:45]
    v_cndmask_b32 v106, v106, v107, s[44:45]
    s_nop 0
    v_add_f32_dpp v104, v104, v104 quad_perm:[2,3,0,1] row_mask:0xf bank_mask:0xf
    v_add_f32_dpp v106, v106, v106 quad_perm:[2,3,0,1] row_mask:0xf bank_mask:0xf
    v_cndmask_b32 v16, v104, v106, s[46:47]
    v_cvt_pk_bf16_f32 v16, v16, v16
    v_lshlrev_b32 v16, 16, v16
    v_mul_f32 v16, s73, v16
    v_cvt_pk_bf16_f32 v16, v16, v16
    v_lshlrev_b32 v59, 16, v16
    s_waitcnt vmcnt(15)
    v_dot2_f32_bf16 v53, v244, v12, 0
    v_dot2_f32_bf16 v53, v245, v13, v53
    v_dot2_f32_bf16 v53, v246, v14, v53
    v_dot2_f32_bf16 v53, v247, v15, v53
    s_waitcnt vmcnt(2)
    buffer_load_dwordx4 v[244:247], v17, s[8:11], s99 offen offset:1024 nt
    s_waitcnt vmcnt(15)
    v_dot2_f32_bf16 v54, v248, v12, 0
    v_dot2_f32_bf16 v54, v249, v13, v54
    v_dot2_f32_bf16 v54, v250, v14, v54
    v_dot2_f32_bf16 v54, v251, v15, v54
    s_waitcnt vmcnt(2)
    buffer_load_dwordx4 v[248:251], v17, s[8:11], s99 offen offset:2048 nt
    s_waitcnt vmcnt(15)
    v_dot2_f32_bf16 v55, v252, v12, 0
    v_dot2_f32_bf16 v55, v253, v13, v55
    v_dot2_f32_bf16 v55, v254, v14, v55
    v_dot2_f32_bf16 v55, v255, v15, v55
    s_waitcnt vmcnt(2)
    buffer_load_dwordx4 v[252:255], v17, s[8:11], s99 offen offset:3072 nt
    v_add_f32_dpp v40, v40, v40 row_ror:8 row_mask:0xf bank_mask:0x3
    v_add_f32_dpp v41, v41, v41 row_ror:8 row_mask:0xf bank_mask:0x3
    v_add_f32_dpp v42, v42, v42 row_ror:8 row_mask:0xf bank_mask:0x3
    v_add_f32_dpp v43, v43, v43 row_ror:8 row_mask:0xf bank_mask:0x3
    v_add_f32_dpp v44, v44, v44 row_ror:8 row_mask:0xf bank_mask:0x3
    v_add_f32_dpp v45, v45, v45 row_ror:8 row_mask:0xf bank_mask:0x3
    v_add_f32_dpp v46, v46, v46 row_ror:8 row_mask:0xf bank_mask:0x3
    v_add_f32_dpp v47, v47, v47 row_ror:8 row_mask:0xf bank_mask:0x3
    v_add_f32_dpp v40, v48, v48 row_ror:8 row_mask:0xf bank_mask:0xc
    v_add_f32_dpp v41, v49, v49 row_ror:8 row_mask:0xf bank_mask:0xc
    v_add_f32_dpp v42, v50, v50 row_ror:8 row_mask:0xf bank_mask:0xc
    v_add_f32_dpp v43, v51, v51 row_ror:8 row_mask:0xf bank_mask:0xc
    v_add_f32_dpp v44, v52, v52 row_ror:8 row_mask:0xf bank_mask:0xc
    v_add_f32_dpp v45, v53, v53 row_ror:8 row_mask:0xf bank_mask:0xc
    v_add_f32_dpp v46, v54, v54 row_ror:8 row_mask:0xf bank_mask:0xc
    v_add_f32_dpp v47, v55, v55 row_ror:8 row_mask:0xf bank_mask:0xc
    v_add_f32_dpp v40, v40, v40 row_half_mirror row_mask:0xf bank_mask:0x5
    v_add_f32_dpp v41, v41, v41 row_half_mirror row_mask:0xf bank_mask:0x5
    v_add_f32_dpp v42, v42, v42 row_half_mirror row_mask:0xf bank_mask:0x5
    v_add_f32_dpp v43, v43, v43 row_half_mirror row_mask:0xf bank_mask:0x5
    v_add_f32_dpp v40, v44, v44 row_half_mirror row_mask:0xf bank_mask:0xa
    v_add_f32_dpp v41, v45, v45 row_half_mirror row_mask:0xf bank_mask:0xa
    v_add_f32_dpp v42, v46, v46 row_half_mirror row_mask:0xf bank_mask:0xa
    v_add_f32_dpp v43, v47, v47 row_half_mirror row_mask:0xf bank_mask:0xa
    v_add_f32_dpp v40, v40, v40 quad_perm:[1,0,3,2] row_mask:0xf bank_mask:0xf
    v_add_f32_dpp v41, v41, v41 quad_perm:[1,0,3,2] row_mask:0xf bank_mask:0xf
    v_add_f32_dpp v42, v42, v42 quad_perm:[1,0,3,2] row_mask:0xf bank_mask:0xf
    v_add_f32_dpp v43, v43, v43 quad_perm:[1,0,3,2] row_mask:0xf bank_mask:0xf
    v_cndmask_b32 v40, v40, v41, s[44:45]
    v_cndmask_b32 v42, v42, v43, s[44:45]
    s_nop 0
    v_add_f32_dpp v40, v40, v40 quad_perm:[2,3,0,1] row_mask:0xf bank_mask:0xf
    v_add_f32_dpp v42, v42, v42 quad_perm:[2,3,0,1] row_mask:0xf bank_mask:0xf
    v_cndmask_b32 v16, v40, v42, s[46:47]
    v_cvt_pk_bf16_f32 v16, v16, v16
    v_lshlrev_b32 v16, 16, v16
    v_mul_f32 v16, s73, v16
    v_cvt_pk_bf16_f32 v16, v16, v16
    v_lshlrev_b32 v58, 16, v16
    v_max_f32 v38, v56, v57
    v_max3_f32 v38, v58, v59, v38
    s_nop 1
    v_max_f32_dpp v38, v38, v38 quad_perm:[1,0,3,2] row_mask:0xf bank_mask:0xf
    s_nop 1
    v_max_f32_dpp v38, v38, v38 quad_perm:[2,3,0,1] row_mask:0xf bank_mask:0xf
    s_nop 1
    v_max_f32_dpp v38, v38, v38 row_half_mirror row_mask:0xf bank_mask:0xf
    s_nop 1
    v_max_f32_dpp v38, v38, v38 row_mirror row_mask:0xf bank_mask:0xf
    v_mov_b32 v40, v38
    s_nop 1
    v_permlane16_swap_b32 v38, v40
    v_max_f32 v38, v38, v40
    v_mov_b32 v40, v38
    s_nop 1
    v_permlane32_swap_b32 v38, v40
    v_max_f32 v38, v38, v40
    v_sub_f32 v56, v56, v38
    v_sub_f32 v57, v57, v38
    v_sub_f32 v58, v58, v38
    v_sub_f32 v59, v59, v38
    v_mul_f32 v56, s72, v56
    v_mul_f32 v57, s72, v57
    v_mul_f32 v58, s72, v58
    v_mul_f32 v59, s72, v59
    v_exp_f32 v56, v56
    v_exp_f32 v57, v57
    v_exp_f32 v58, v58
    v_exp_f32 v59, v59
    v_mov_b32 v20, 0
    v_mov_b32 v21, 0
    v_mov_b32 v22, 0
    v_mov_b32 v23, 0
    v_add_f32 v39, v56, v57
    v_add_f32 v40, v58, v59
    v_add_f32 v39, v39, v40
    v_cvt_pk_bf16_f32 v40, v56, v56
    v_lshlrev_b32 v40, 16, v40
    v_sub_f32 v40, v56, v40
    v_cvt_pk_bf16_f32 v56, v56, v40
    v_cvt_pk_bf16_f32 v41, v57, v57
    v_lshlrev_b32 v41, 16, v41
    v_sub_f32 v41, v57, v41
    v_cvt_pk_bf16_f32 v57, v57, v41
    v_cvt_pk_bf16_f32 v42, v58, v58
    v_lshlrev_b32 v42, 16, v42
    v_sub_f32 v42, v58, v42
    v_cvt_pk_bf16_f32 v58, v58, v42
    v_cvt_pk_bf16_f32 v43, v59, v59
    v_lshlrev_b32 v43, 16, v43
    v_sub_f32 v43, v59, v43
    v_cvt_pk_bf16_f32 v59, v59, v43
    s_lshl_b32 s69, s75, 12
    s_add_u32 s61, s64, 16
    s_add_u32 s96, s61, 0
    s_and_b32 s96, s96, 63
    s_lshl_b32 s96, s96, 15
    s_add_u32 s97, s61, 4
    s_and_b32 s97, s97, 63
    s_lshl_b32 s97, s97, 15
    s_add_u32 s98, s61, 8
    s_and_b32 s98, s98, 63
    s_lshl_b32 s98, s98, 15
    s_add_u32 s99, s61, 12
    s_and_b32 s99, s99, 63
    s_lshl_b32 s99, s99, 15
    v_mov_b32_dpp v32, v56 row_newbcast:0 row_mask:0xf bank_mask:0xf
    v_perm_b32 v24, v32, v32, v8
    v_perm_b32 v25, v32, v32, v9
    v_perm_b32 v26, v32, v32, v10
    v_perm_b32 v27, v32, v32, v11
    v_mov_b32_dpp v33, v56 row_newbcast:1 row_mask:0xf bank_mask:0xf
    v_perm_b32 v28, v33, v33, v8
    v_perm_b32 v29, v33, v33, v9
    v_perm_b32 v30, v33, v33, v10
    v_perm_b32 v31, v33, v33, v11
    s_waitcnt vmcnt(15)
    v_mfma_f32_16x16x32_bf16 v[20:23], v[24:27], v[192:195], v[20:23]
    s_add_u32 s62, s58, s69
    buffer_load_dwordx4 v[128:131], v4, s[20:23], s62 offen
    s_add_u32 s69, s69, 4096
    s_and_b32 s69, s69, 0xffff
    s_waitcnt vmcnt(3)
    buffer_load_dwordx4 v[192:195], v17, s[8:11], s96 offen nt
    v_mov_b32_dpp v32, v56 row_newbcast:2 row_mask:0xf bank_mask:0xf
    v_perm_b32 v24, v32, v32, v8
    v_perm_b32 v25, v32, v32, v9
    v_perm_b32 v26, v32, v32, v10
    v_perm_b32 v27, v32, v32, v11
    s_waitcnt vmcnt(15)
    v_mfma_f32_16x16x32_bf16 v[20:23], v[28:31], v[196:199], v[20:23]
    s_waitcnt vmcnt(3)
    buffer_load_dwordx4 v[196:199], v17, s[8:11], s96 offen offset:1024 nt
    v_mov_b32_dpp v33, v56 row_newbcast:3 row_mask:0xf bank_mask:0xf
    v_perm_b32 v28, v33, v33, v8
    v_perm_b32 v29, v33, v33, v9
    v_perm_b32 v30, v33, v33, v10
    v_perm_b32 v31, v33, v33, v11
    s_waitcnt vmcnt(15)
    v_mfma_f32_16x16x32_bf16 v[20:23], v[24:27], v[200:203], v[20:23]
    s_waitcnt vmcnt(3)
    buffer_load_dwordx4 v[200:203], v17, s[8:11], s96 offen offset:2048 nt
    v_add_f32_dpp v39, v39, v39 quad_perm:[1,0,3,2] row_mask:0xf bank_mask:0xf
    s_nop 1
    v_add_f32_dpp v39, v39, v39 quad_perm:[2,3,0,1] row_mask:0xf bank_mask:0xf
    s_nop 1
    v_add_f32_dpp v39, v39, v39 row_half_mirror row_mask:0xf bank_mask:0xf
    s_nop 1
    v_add_f32_dpp v39, v39, v39 row_mirror row_mask:0xf bank_mask:0xf
    v_mov_b32 v44, v39
    s_nop 1
    v_permlane16_swap_b32 v39, v44
    v_add_f32 v39, v39, v44
    v_mov_b32 v44, v39
    s_nop 1
    v_permlane32_swap_b32 v39, v44
    v_add_f32 v39, v39, v44
    s_lshl_b32 s61, s54, 3
    v_mov_b32 v45, s61
    ds_write_b64 v45, v[38:39] offset:5120
    v_mov_b32_dpp v32, v56 row_newbcast:4 row_mask:0xf bank_mask:0xf
    v_perm_b32 v24, v32, v32, v8
    v_perm_b32 v25, v32, v32, v9
    v_perm_b32 v26, v32, v32, v10
    v_perm_b32 v27, v32, v32, v11
    s_waitcnt vmcnt(15)
    v_mfma_f32_16x16x32_bf16 v[20:23], v[28:31], v[204:207], v[20:23]
    s_add_u32 s62, s58, s69
    buffer_load_dwordx4 v[132:135], v4, s[20:23], s62 offen
    s_add_u32 s69, s69, 4096
    s_and_b32 s69, s69, 0xffff
    s_waitcnt vmcnt(3)
    buffer_load_dwordx4 v[204:207], v17, s[8:11], s96 offen offset:3072 nt
    v_mov_b32_dpp v33, v56 row_newbcast:5 row_mask:0xf bank_mask:0xf
    v_perm_b32 v28, v33, v33, v8
    v_perm_b32 v29, v33, v33, v9
    v_perm_b32 v30, v33, v33, v10
    v_perm_b32 v31, v33, v33, v11
    s_waitcnt vmcnt(15)
    v_mfma_f32_16x16x32_bf16 v[20:23], v[24:27], v[208:211], v[20:23]
    s_waitcnt vmcnt(3)
    buffer_load_dwordx4 v[208:211], v17, s[8:11], s97 offen nt
    v_mov_b32_dpp v32, v56 row_newbcast:6 row_mask:0xf bank_mask:0xf
    v_perm_b32 v24, v32, v32, v8
    v_perm_b32 v25, v32, v32, v9
    v_perm_b32 v26, v32, v32, v10
    v_perm_b32 v27, v32, v32, v11
    s_waitcnt vmcnt(15)
    v_mfma_f32_16x16x32_bf16 v[20:23], v[28:31], v[212:215], v[20:23]
    s_waitcnt vmcnt(3)
    buffer_load_dwordx4 v[212:215], v17, s[8:11], s97 offen offset:1024 nt
    v_mov_b32_dpp v33, v56 row_newbcast:7 row_mask:0xf bank_mask:0xf
    v_perm_b32 v28, v33, v33, v8
    v_perm_b32 v29, v33, v33, v9
    v_perm_b32 v30, v33, v33, v10
    v_perm_b32 v31, v33, v33, v11
    s_waitcnt vmcnt(15)
    v_mfma_f32_16x16x32_bf16 v[20:23], v[24:27], v[216:219], v[20:23]
    s_add_u32 s62, s58, s69
    buffer_load_dwordx4 v[136:139], v4, s[20:23], s62 offen
    s_add_u32 s69, s69, 4096
    s_and_b32 s69, s69, 0xffff
    s_waitcnt vmcnt(3)
    buffer_load_dwordx4 v[216:219], v17, s[8:11], s97 offen offset:2048 nt
    v_mov_b32_dpp v32, v56 row_newbcast:8 row_mask:0xf bank_mask:0xf
    v_perm_b32 v24, v32, v32, v8
    v_perm_b32 v25, v32, v32, v9
    v_perm_b32 v26, v32, v32, v10
    v_perm_b32 v27, v32, v32, v11
    s_waitcnt vmcnt(15)
    v_mfma_f32_16x16x32_bf16 v[20:23], v[28:31], v[220:223], v[20:23]
    s_waitcnt vmcnt(3)
    buffer_load_dwordx4 v[220:223], v17, s[8:11], s97 offen offset:3072 nt
    v_mov_b32_dpp v33, v56 row_newbcast:9 row_mask:0xf bank_mask:0xf
    v_perm_b32 v28, v33, v33, v8
    v_perm_b32 v29, v33, v33, v9
    v_perm_b32 v30, v33, v33, v10
    v_perm_b32 v31, v33, v33, v11
    s_waitcnt vmcnt(15)
    v_mfma_f32_16x16x32_bf16 v[20:23], v[24:27], v[224:227], v[20:23]
    s_waitcnt vmcnt(3)
    buffer_load_dwordx4 v[224:227], v17, s[8:11], s98 offen nt
    v_mov_b32_dpp v32, v56 row_newbcast:10 row_mask:0xf bank_mask:0xf
    v_perm_b32 v24, v32, v32, v8
    v_perm_b32 v25, v32, v32, v9
    v_perm_b32 v26, v32, v32, v10
    v_perm_b32 v27, v32, v32, v11
    s_waitcnt vmcnt(15)
    v_mfma_f32_16x16x32_bf16 v[20:23], v[28:31], v[228:231], v[20:23]
    s_add_u32 s62, s58, s69
    buffer_load_dwordx4 v[140:143], v4, s[20:23], s62 offen
    s_add_u32 s69, s69, 4096
    s_and_b32 s69, s69, 0xffff
    s_waitcnt vmcnt(3)
    buffer_load_dwordx4 v[228:231], v17, s[8:11], s98 offen offset:1024 nt
    v_mov_b32_dpp v33, v56 row_newbcast:11 row_mask:0xf bank_mask:0xf
    v_perm_b32 v28, v33, v33, v8
    v_perm_b32 v29, v33, v33, v9
    v_perm_b32 v30, v33, v33, v10
    v_perm_b32 v31, v33, v33, v11
    s_waitcnt vmcnt(15)
    v_mfma_f32_16x16x32_bf16 v[20:23], v[24:27], v[232:235], v[20:23]
    s_waitcnt vmcnt(3)
    buffer_load_dwordx4 v[232:235], v17, s[8:11], s98 offen offset:2048 nt
    v_mov_b32_dpp v32, v56 row_newbcast:12 row_mask:0xf bank_mask:0xf
    v_perm_b32 v24, v32, v32, v8
    v_perm_b32 v25, v32, v32, v9
    v_perm_b32 v26, v32, v32, v10
    v_perm_b32 v27, v32, v32, v11
    s_waitcnt vmcnt(15)
    v_mfma_f32_16x16x32_bf16 v[20:23], v[28:31], v[236:239], v[20:23]
    s_waitcnt vmcnt(3)
    buffer_load_dwordx4 v[236:239], v17, s[8:11], s98 offen offset:3072 nt
    v_mov_b32_dpp v33, v56 row_newbcast:13 row_mask:0xf bank_mask:0xf
    v_perm_b32 v28, v33, v33, v8
    v_perm_b32 v29, v33, v33, v9
    v_perm_b32 v30, v33, v33, v10
    v_perm_b32 v31, v33, v33, v11
    s_waitcnt vmcnt(15)
    v_mfma_f32_16x16x32_bf16 v[20:23], v[24:27], v[240:243], v[20:23]
    s_add_u32 s62, s58, s69
    buffer_load_dwordx4 v[144:147], v4, s[20:23], s62 offen
    s_add_u32 s69, s69, 4096
    s_and_b32 s69, s69, 0xffff
    s_waitcnt vmcnt(3)
    buffer_load_dwordx4 v[240:243], v17, s[8:11], s99 offen nt
    v_mov_b32_dpp v32, v56 row_newbcast:14 row_mask:0xf bank_mask:0xf
    v_perm_b32 v24, v32, v32, v8
    v_perm_b32 v25, v32, v32, v9
    v_perm_b32 v26, v32, v32, v10
    v_perm_b32 v27, v32, v32, v11
    s_waitcnt vmcnt(15)
    v_mfma_f32_16x16x32_bf16 v[20:23], v[28:31], v[244:247], v[20:23]
    s_waitcnt vmcnt(3)
    buffer_load_dwordx4 v[244:247], v17, s[8:11], s99 offen offset:1024 nt
    v_mov_b32_dpp v33, v56 row_newbcast:15 row_mask:0xf bank_mask:0xf
    v_perm_b32 v28, v33, v33, v8
    v_perm_b32 v29, v33, v33, v9
    v_perm_b32 v30, v33, v33, v10
    v_perm_b32 v31, v33, v33, v11
    s_waitcnt vmcnt(15)
    v_mfma_f32_16x16x32_bf16 v[20:23], v[24:27], v[248:251], v[20:23]
    s_waitcnt vmcnt(3)
    buffer_load_dwordx4 v[248:251], v17, s[8:11], s99 offen offset:2048 nt
    s_waitcnt vmcnt(15)
    v_mfma_f32_16x16x32_bf16 v[20:23], v[28:31], v[252:255], v[20:23]
    s_add_u32 s62, s58, s69
    buffer_load_dwordx4 v[148:151], v4, s[20:23], s62 offen
    s_add_u32 s69, s69, 4096
    s_and_b32 s69, s69, 0xffff
    s_waitcnt vmcnt(3)
    buffer_load_dwordx4 v[252:255], v17, s[8:11], s99 offen offset:3072 nt
    s_add_u32 s61, s64, 32
    s_add_u32 s96, s61, 0
    s_and_b32 s96, s96, 63
    s_lshl_b32 s96, s96, 15
    s_add_u32 s97, s61, 4
    s_and_b32 s97, s97, 63
    s_lshl_b32 s97, s97, 15
    s_add_u32 s98, s61, 8
    s_and_b32 s98, s98, 63
    s_lshl_b32 s98, s98, 15
    s_add_u32 s99, s61, 12
    s_and_b32 s99, s99, 63
    s_lshl_b32 s99, s99, 15
    v_mov_b32_dpp v32, v57 row_newbcast:0 row_mask:0xf bank_mask:0xf
    v_perm_b32 v24, v32, v32, v8
    v_perm_b32 v25, v32, v32, v9
    v_perm_b32 v26, v32, v32, v10
    v_perm_b32 v27, v32, v32, v11
    v_mov_b32_dpp v33, v57 row_newbcast:1 row_mask:0xf bank_mask:0xf
    v_perm_b32 v28, v33, v33, v8
    v_perm_b32 v29, v33, v33, v9
    v_perm_b32 v30, v33, v33, v10
    v_perm_b32 v31, v33, v33, v11
    s_waitcnt vmcnt(15)
    v_mfma_f32_16x16x32_bf16 v[20:23], v[24:27], v[192:195], v[20:23]
    s_waitcnt vmcnt(3)
    buffer_load_dwordx4 v[192:195], v17, s[8:11], s96 offen nt
    v_mov_b32_dpp v32, v57 row_newbcast:2 row_mask:0xf bank_mask:0xf
    v_perm_b32 v24, v32, v32, v8
    v_perm_b32 v25, v32, v32, v9
    v_perm_b32 v26, v32, v32, v10
    v_perm_b32 v27, v32, v32, v11
    s_waitcnt vmcnt(15)
    v_mfma_f32_16x16x32_bf16 v[20:23], v[28:31], v[196:199], v[20:23]
    s_waitcnt vmcnt(3)
    buffer_load_dwordx4 v[196:199], v17, s[8:11], s96 offen offset:1024 nt
    v_mov_b32_dpp v33, v57 row_newbcast:3 row_mask:0xf bank_mask:0xf
    v_perm_b32 v28, v33, v33, v8
    v_perm_b32 v29, v33, v33, v9
    v_perm_b32 v30, v33, v33, v10
    v_perm_b32 v31, v33, v33, v11
    s_waitcnt vmcnt(15)
    v_mfma_f32_16x16x32_bf16 v[20:23], v[24:27], v[200:203], v[20:23]
    s_add_u32 s62, s58, s69
    buffer_load_dwordx4 v[152:155], v4, s[20:23], s62 offen
    s_add_u32 s69, s69, 4096
    s_and_b32 s69, s69, 0xffff
    s_waitcnt vmcnt(3)
    buffer_load_dwordx4 v[200:203], v17, s[8:11], s96 offen offset:2048 nt
    v_mov_b32_dpp v32, v57 row_newbcast:4 row_mask:0xf bank_mask:0xf
    v_perm_b32 v24, v32, v32, v8
    v_perm_b32 v25, v32, v32, v9
    v_perm_b32 v26, v32, v32, v10
    v_perm_b32 v27, v32, v32, v11
    s_waitcnt vmcnt(15)
    v_mfma_f32_16x16x32_bf16 v[20:23], v[28:31], v[204:207], v[20:23]
    s_waitcnt vmcnt(3)
    buffer_load_dwordx4 v[204:207], v17, s[8:11], s96 offen offset:3072 nt
    v_mov_b32_dpp v33, v57 row_newbcast:5 row_mask:0xf bank_mask:0xf
    v_perm_b32 v28, v33, v33, v8
    v_perm_b32 v29, v33, v33, v9
    v_perm_b32 v30, v33, v33, v10
    v_perm_b32 v31, v33, v33, v11
    s_waitcnt vmcnt(15)
    v_mfma_f32_16x16x32_bf16 v[20:23], v[24:27], v[208:211], v[20:23]
    s_waitcnt vmcnt(3)
    buffer_load_dwordx4 v[208:211], v17, s[8:11], s97 offen nt
    v_mov_b32_dpp v32, v57 row_newbcast:6 row_mask:0xf bank_mask:0xf
    v_perm_b32 v24, v32, v32, v8
    v_perm_b32 v25, v32, v32, v9
    v_perm_b32 v26, v32, v32, v10
    v_perm_b32 v27, v32, v32, v11
    s_waitcnt vmcnt(15)
    v_mfma_f32_16x16x32_bf16 v[20:23], v[28:31], v[212:215], v[20:23]
    s_add_u32 s62, s58, s69
    buffer_load_dwordx4 v[156:159], v4, s[20:23], s62 offen
    s_add_u32 s69, s69, 4096
    s_and_b32 s69, s69, 0xffff
    s_waitcnt vmcnt(3)
    buffer_load_dwordx4 v[212:215], v17, s[8:11], s97 offen offset:1024 nt
    v_mov_b32_dpp v33, v57 row_newbcast:7 row_mask:0xf bank_mask:0xf
    v_perm_b32 v28, v33, v33, v8
    v_perm_b32 v29, v33, v33, v9
    v_perm_b32 v30, v33, v33, v10
    v_perm_b32 v31, v33, v33, v11
    s_waitcnt vmcnt(15)
    v_mfma_f32_16x16x32_bf16 v[20:23], v[24:27], v[216:219], v[20:23]
    s_waitcnt vmcnt(3)
    buffer_load_dwordx4 v[216:219], v17, s[8:11], s97 offen offset:2048 nt
    v_mov_b32_dpp v32, v57 row_newbcast:8 row_mask:0xf bank_mask:0xf
    v_perm_b32 v24, v32, v32, v8
    v_perm_b32 v25, v32, v32, v9
    v_perm_b32 v26, v32, v32, v10
    v_perm_b32 v27, v32, v32, v11
    s_waitcnt vmcnt(15)
    v_mfma_f32_16x16x32_bf16 v[20:23], v[28:31], v[220:223], v[20:23]
    s_waitcnt vmcnt(3)
    buffer_load_dwordx4 v[220:223], v17, s[8:11], s97 offen offset:3072 nt
    v_mov_b32_dpp v33, v57 row_newbcast:9 row_mask:0xf bank_mask:0xf
    v_perm_b32 v28, v33, v33, v8
    v_perm_b32 v29, v33, v33, v9
    v_perm_b32 v30, v33, v33, v10
    v_perm_b32 v31, v33, v33, v11
    s_waitcnt vmcnt(15)
    v_mfma_f32_16x16x32_bf16 v[20:23], v[24:27], v[224:227], v[20:23]
    s_add_u32 s62, s58, s69
    buffer_load_dwordx4 v[160:163], v4, s[20:23], s62 offen
    s_add_u32 s69, s69, 4096
    s_and_b32 s69, s69, 0xffff
    s_waitcnt vmcnt(3)
    buffer_load_dwordx4 v[224:227], v17, s[8:11], s98 offen nt
    v_mov_b32_dpp v32, v57 row_newbcast:10 row_mask:0xf bank_mask:0xf
    v_perm_b32 v24, v32, v32, v8
    v_perm_b32 v25, v32, v32, v9
    v_perm_b32 v26, v32, v32, v10
    v_perm_b32 v27, v32, v32, v11
    s_waitcnt vmcnt(15)
    v_mfma_f32_16x16x32_bf16 v[20:23], v[28:31], v[228:231], v[20:23]
    s_waitcnt vmcnt(3)
    buffer_load_dwordx4 v[228:231], v17, s[8:11], s98 offen offset:1024 nt
    v_mov_b32_dpp v33, v57 row_newbcast:11 row_mask:0xf bank_mask:0xf
    v_perm_b32 v28, v33, v33, v8
    v_perm_b32 v29, v33, v33, v9
    v_perm_b32 v30, v33, v33, v10
    v_perm_b32 v31, v33, v33, v11
    s_waitcnt vmcnt(15)
    v_mfma_f32_16x16x32_bf16 v[20:23], v[24:27], v[232:235], v[20:23]
    s_waitcnt vmcnt(3)
    buffer_load_dwordx4 v[232:235], v17, s[8:11], s98 offen offset:2048 nt
    v_mov_b32_dpp v32, v57 row_newbcast:12 row_mask:0xf bank_mask:0xf
    v_perm_b32 v24, v32, v32, v8
    v_perm_b32 v25, v32, v32, v9
    v_perm_b32 v26, v32, v32, v10
    v_perm_b32 v27, v32, v32, v11
    s_waitcnt vmcnt(15)
    v_mfma_f32_16x16x32_bf16 v[20:23], v[28:31], v[236:239], v[20:23]
    s_add_u32 s62, s58, s69
    buffer_load_dwordx4 v[164:167], v4, s[20:23], s62 offen
    s_add_u32 s69, s69, 4096
    s_and_b32 s69, s69, 0xffff
    s_waitcnt vmcnt(3)
    buffer_load_dwordx4 v[236:239], v17, s[8:11], s98 offen offset:3072 nt
    v_mov_b32_dpp v33, v57 row_newbcast:13 row_mask:0xf bank_mask:0xf
    v_perm_b32 v28, v33, v33, v8
    v_perm_b32 v29, v33, v33, v9
    v_perm_b32 v30, v33, v33, v10
    v_perm_b32 v31, v33, v33, v11
    s_waitcnt vmcnt(15)
    v_mfma_f32_16x16x32_bf16 v[20:23], v[24:27], v[240:243], v[20:23]
    s_waitcnt vmcnt(3)
    buffer_load_dwordx4 v[240:243], v17, s[8:11], s99 offen nt
    v_mov_b32_dpp v32, v57 row_newbcast:14 row_mask:0xf bank_mask:0xf
    v_perm_b32 v24, v32, v32, v8
    v_perm_b32 v25, v32, v32, v9
    v_perm_b32 v26, v32, v32, v10
    v_perm_b32 v27, v32, v32, v11
    s_waitcnt vmcnt(15)
    v_mfma_f32_16x16x32_bf16 v[20:23], v[28:31], v[244:247], v[20:23]
    s_waitcnt vmcnt(3)
    buffer_load_dwordx4 v[244:247], v17, s[8:11], s99 offen offset:1024 nt
    v_mov_b32_dpp v33, v57 row_newbcast:15 row_mask:0xf bank_mask:0xf
    v_perm_b32 v28, v33, v33, v8
    v_perm_b32 v29, v33, v33, v9
    v_perm_b32 v30, v33, v33, v10
    v_perm_b32 v31, v33, v33, v11
    s_waitcnt vmcnt(15)
    v_mfma_f32_16x16x32_bf16 v[20:23], v[24:27], v[248:251], v[20:23]
    s_add_u32 s62, s58, s69
    buffer_load_dwordx4 v[168:171], v4, s[20:23], s62 offen
    s_add_u32 s69, s69, 4096
    s_and_b32 s69, s69, 0xffff
    s_waitcnt vmcnt(3)
    buffer_load_dwordx4 v[248:251], v17, s[8:11], s99 offen offset:2048 nt
    s_waitcnt vmcnt(15)
    v_mfma_f32_16x16x32_bf16 v[20:23], v[28:31], v[252:255], v[20:23]
    s_waitcnt vmcnt(3)
    buffer_load_dwordx4 v[252:255], v17, s[8:11], s99 offen offset:3072 nt
    s_add_u32 s61, s64, 48
    s_add_u32 s96, s61, 0
    s_and_b32 s96, s96, 63
    s_lshl_b32 s96, s96, 15
    s_add_u32 s97, s61, 4
    s_and_b32 s97, s97, 63
    s_lshl_b32 s97, s97, 15
    s_add_u32 s98, s61, 8
    s_and_b32 s98, s98, 63
    s_lshl_b32 s98, s98, 15
    s_add_u32 s99, s61, 12
    s_and_b32 s99, s99, 63
    s_lshl_b32 s99, s99, 15
    v_mov_b32_dpp v32, v58 row_newbcast:0 row_mask:0xf bank_mask:0xf
    v_perm_b32 v24, v32, v32, v8
    v_perm_b32 v25, v32, v32, v9
    v_perm_b32 v26, v32, v32, v10
    v_perm_b32 v27, v32, v32, v11
    v_mov_b32_dpp v33, v58 row_newbcast:1 row_mask:0xf bank_mask:0xf
    v_perm_b32 v28, v33, v33, v8
    v_perm_b32 v29, v33, v33, v9
    v_perm_b32 v30, v33, v33, v10
    v_perm_b32 v31, v33, v33, v11
    s_waitcnt vmcnt(15)
    v_mfma_f32_16x16x32_bf16 v[20:23], v[24:27], v[192:195], v[20:23]
    s_waitcnt vmcnt(3)
    buffer_load_dwordx4 v[192:195], v17, s[8:11], s96 offen nt
    v_mov_b32_dpp v32, v58 row_newbcast:2 row_mask:0xf bank_mask:0xf
    v_perm_b32 v24, v32, v32, v8
    v_perm_b32 v25, v32, v32, v9
    v_perm_b32 v26, v32, v32, v10
    v_perm_b32 v27, v32, v32, v11
    s_waitcnt vmcnt(15)
    v_mfma_f32_16x16x32_bf16 v[20:23], v[28:31], v[196:199], v[20:23]
    s_add_u32 s62, s58, s69
    buffer_load_dwordx4 v[172:175], v4, s[20:23], s62 offen
    s_add_u32 s69, s69, 4096
    s_and_b32 s69, s69, 0xffff
    s_waitcnt vmcnt(3)
    buffer_load_dwordx4 v[196:199], v17, s[8:11], s96 offen offset:1024 nt
    v_mov_b32_dpp v33, v58 row_newbcast:3 row_mask:0xf bank_mask:0xf
    v_perm_b32 v28, v33, v33, v8
    v_perm_b32 v29, v33, v33, v9
    v_perm_b32 v30, v33, v33, v10
    v_perm_b32 v31, v33, v33, v11
    s_waitcnt vmcnt(15)
    v_mfma_f32_16x16x32_bf16 v[20:23], v[24:27], v[200:203], v[20:23]
    s_waitcnt vmcnt(3)
    buffer_load_dwordx4 v[200:203], v17, s[8:11], s96 offen offset:2048 nt
    v_mov_b32_dpp v32, v58 row_newbcast:4 row_mask:0xf bank_mask:0xf
    v_perm_b32 v24, v32, v32, v8
    v_perm_b32 v25, v32, v32, v9
    v_perm_b32 v26, v32, v32, v10
    v_perm_b32 v27, v32, v32, v11
    s_waitcnt vmcnt(15)
    v_mfma_f32_16x16x32_bf16 v[20:23], v[28:31], v[204:207], v[20:23]
    s_waitcnt vmcnt(3)
    buffer_load_dwordx4 v[204:207], v17, s[8:11], s96 offen offset:3072 nt
    v_mov_b32_dpp v33, v58 row_newbcast:5 row_mask:0xf bank_mask:0xf
    v_perm_b32 v28, v33, v33, v8
    v_perm_b32 v29, v33, v33, v9
    v_perm_b32 v30, v33, v33, v10
    v_perm_b32 v31, v33, v33, v11
    s_waitcnt vmcnt(15)
    v_mfma_f32_16x16x32_bf16 v[20:23], v[24:27], v[208:211], v[20:23]
    s_add_u32 s62, s58, s69
    buffer_load_dwordx4 v[176:179], v4, s[20:23], s62 offen
    s_add_u32 s69, s69, 4096
    s_and_b32 s69, s69, 0xffff
    s_waitcnt vmcnt(3)
    buffer_load_dwordx4 v[208:211], v17, s[8:11], s97 offen nt
    v_mov_b32_dpp v32, v58 row_newbcast:6 row_mask:0xf bank_mask:0xf
    v_perm_b32 v24, v32, v32, v8
    v_perm_b32 v25, v32, v32, v9
    v_perm_b32 v26, v32, v32, v10
    v_perm_b32 v27, v32, v32, v11
    s_waitcnt vmcnt(15)
    v_mfma_f32_16x16x32_bf16 v[20:23], v[28:31], v[212:215], v[20:23]
    s_waitcnt vmcnt(3)
    buffer_load_dwordx4 v[212:215], v17, s[8:11], s97 offen offset:1024 nt
    v_mov_b32_dpp v33, v58 row_newbcast:7 row_mask:0xf bank_mask:0xf
    v_perm_b32 v28, v33, v33, v8
    v_perm_b32 v29, v33, v33, v9
    v_perm_b32 v30, v33, v33, v10
    v_perm_b32 v31, v33, v33, v11
    s_waitcnt vmcnt(15)
    v_mfma_f32_16x16x32_bf16 v[20:23], v[24:27], v[216:219], v[20:23]
    s_waitcnt vmcnt(3)
    buffer_load_dwordx4 v[216:219], v17, s[8:11], s97 offen offset:2048 nt
    v_mov_b32_dpp v32, v58 row_newbcast:8 row_mask:0xf bank_mask:0xf
    v_perm_b32 v24, v32, v32, v8
    v_perm_b32 v25, v32, v32, v9
    v_perm_b32 v26, v32, v32, v10
    v_perm_b32 v27, v32, v32, v11
    s_waitcnt vmcnt(15)
    v_mfma_f32_16x16x32_bf16 v[20:23], v[28:31], v[220:223], v[20:23]
    s_add_u32 s62, s58, s69
    buffer_load_dwordx4 v[180:183], v4, s[20:23], s62 offen
    s_add_u32 s69, s69, 4096
    s_and_b32 s69, s69, 0xffff
    s_waitcnt vmcnt(3)
    buffer_load_dwordx4 v[220:223], v17, s[8:11], s97 offen offset:3072 nt
    v_mov_b32_dpp v33, v58 row_newbcast:9 row_mask:0xf bank_mask:0xf
    v_perm_b32 v28, v33, v33, v8
    v_perm_b32 v29, v33, v33, v9
    v_perm_b32 v30, v33, v33, v10
    v_perm_b32 v31, v33, v33, v11
    s_waitcnt vmcnt(15)
    v_mfma_f32_16x16x32_bf16 v[20:23], v[24:27], v[224:227], v[20:23]
    s_waitcnt vmcnt(3)
    buffer_load_dwordx4 v[224:227], v17, s[8:11], s98 offen nt
    v_mov_b32_dpp v32, v58 row_newbcast:10 row_mask:0xf bank_mask:0xf
    v_perm_b32 v24, v32, v32, v8
    v_perm_b32 v25, v32, v32, v9
    v_perm_b32 v26, v32, v32, v10
    v_perm_b32 v27, v32, v32, v11
    s_waitcnt vmcnt(15)
    v_mfma_f32_16x16x32_bf16 v[20:23], v[28:31], v[228:231], v[20:23]
    s_waitcnt vmcnt(3)
    buffer_load_dwordx4 v[228:231], v17, s[8:11], s98 offen offset:1024 nt
    v_mov_b32_dpp v33, v58 row_newbcast:11 row_mask:0xf bank_mask:0xf
    v_perm_b32 v28, v33, v33, v8
    v_perm_b32 v29, v33, v33, v9
    v_perm_b32 v30, v33, v33, v10
    v_perm_b32 v31, v33, v33, v11
    s_waitcnt vmcnt(15)
    v_mfma_f32_16x16x32_bf16 v[20:23], v[24:27], v[232:235], v[20:23]
    s_add_u32 s62, s58, s69
    buffer_load_dwordx4 v[184:187], v4, s[20:23], s62 offen
    s_add_u32 s69, s69, 4096
    s_and_b32 s69, s69, 0xffff
    s_waitcnt vmcnt(3)
    buffer_load_dwordx4 v[232:235], v17, s[8:11], s98 offen offset:2048 nt
    v_mov_b32_dpp v32, v58 row_newbcast:12 row_mask:0xf bank_mask:0xf
    v_perm_b32 v24, v32, v32, v8
    v_perm_b32 v25, v32, v32, v9
    v_perm_b32 v26, v32, v32, v10
    v_perm_b32 v27, v32, v32, v11
    s_waitcnt vmcnt(15)
    v_mfma_f32_16x16x32_bf16 v[20:23], v[28:31], v[236:239], v[20:23]
    s_waitcnt vmcnt(3)
    buffer_load_dwordx4 v[236:239], v17, s[8:11], s98 offen offset:3072 nt
    v_mov_b32_dpp v33, v58 row_newbcast:13 row_mask:0xf bank_mask:0xf
    v_perm_b32 v28, v33, v33, v8
    v_perm_b32 v29, v33, v33, v9
    v_perm_b32 v30, v33, v33, v10
    v_perm_b32 v31, v33, v33, v11
    s_waitcnt vmcnt(15)
    v_mfma_f32_16x16x32_bf16 v[20:23], v[24:27], v[240:243], v[20:23]
    s_waitcnt vmcnt(3)
    buffer_load_dwordx4 v[240:243], v17, s[8:11], s99 offen nt
    v_mov_b32_dpp v32, v58 row_newbcast:14 row_mask:0xf bank_mask:0xf
    v_perm_b32 v24, v32, v32, v8
    v_perm_b32 v25, v32, v32, v9
    v_perm_b32 v26, v32, v32, v10
    v_perm_b32 v27, v32, v32, v11
    s_waitcnt vmcnt(15)
    v_mfma_f32_16x16x32_bf16 v[20:23], v[28:31], v[244:247], v[20:23]
    s_add_u32 s62, s58, s69
    buffer_load_dwordx4 v[188:191], v4, s[20:23], s62 offen
    s_waitcnt vmcnt(3)
    buffer_load_dwordx4 v[244:247], v17, s[8:11], s99 offen offset:1024 nt
    v_mov_b32_dpp v33, v58 row_newbcast:15 row_mask:0xf bank_mask:0xf
    v_perm_b32 v28, v33, v33, v8
    v_perm_b32 v29, v33, v33, v9
    v_perm_b32 v30, v33, v33, v10
    v_perm_b32 v31, v33, v33, v11
    s_waitcnt vmcnt(15)
    v_mfma_f32_16x16x32_bf16 v[20:23], v[24:27], v[248:251], v[20:23]
    s_waitcnt vmcnt(3)
    buffer_load_dwordx4 v[248:251], v17, s[8:11], s99 offen offset:2048 nt
    s_waitcnt vmcnt(15)
    v_mfma_f32_16x16x32_bf16 v[20:23], v[28:31], v[252:255], v[20:23]
    s_waitcnt vmcnt(3)
    buffer_load_dwordx4 v[252:255], v17, s[8:11], s99 offen offset:3072 nt
    s_lshl_b32 s61, s54, 9
    v_lshlrev_b32 v72, 2, v7
    v_add_u32 v72, s61, v72
    s_lshr_b32 s62, s54, 2
    s_lshl_b32 s62, s62, 8
    v_lshlrev_b32 v73, 4, v127
    v_lshl_add_u32 v73, v5, 2, v73
    v_add_u32 v73, s62, v73
    v_and_b32 v74, 7, v1
    v_lshlrev_b32 v74, 3, v74
    v_and_b32 v75, 127, v0
    v_lshlrev_b32 v75, 4, v75
    v_mov_b32_dpp v32, v59 row_newbcast:0 row_mask:0xf bank_mask:0xf
    v_perm_b32 v24, v32, v32, v8
    v_perm_b32 v25, v32, v32, v9
    v_perm_b32 v26, v32, v32, v10
    v_perm_b32 v27, v32, v32, v11
    v_mov_b32_dpp v33, v59 row_newbcast:1 row_mask:0xf bank_mask:0xf
    v_perm_b32 v28, v33, v33, v8
    v_perm_b32 v29, v33, v33, v9
    v_perm_b32 v30, v33, v33, v10
    v_perm_b32 v31, v33, v33, v11
    s_waitcnt vmcnt(15)
    v_mfma_f32_16x16x32_bf16 v[20:23], v[24:27], v[192:195], v[20:23]
    v_mov_b32_dpp v32, v59 row_newbcast:2 row_mask:0xf bank_mask:0xf
    v_perm_b32 v24, v32, v32, v8
    v_perm_b32 v25, v32, v32, v9
    v_perm_b32 v26, v32, v32, v10
    v_perm_b32 v27, v32, v32, v11
    s_waitcnt vmcnt(14)
    v_mfma_f32_16x16x32_bf16 v[20:23], v[28:31], v[196:199], v[20:23]
    v_mov_b32_dpp v33, v59 row_newbcast:3 row_mask:0xf bank_mask:0xf
    v_perm_b32 v28, v33, v33, v8
    v_perm_b32 v29, v33, v33, v9
    v_perm_b32 v30, v33, v33, v10
    v_perm_b32 v31, v33, v33, v11
    s_waitcnt vmcnt(13)
    v_mfma_f32_16x16x32_bf16 v[20:23], v[24:27], v[200:203], v[20:23]
    v_mov_b32_dpp v32, v59 row_newbcast:4 row_mask:0xf bank_mask:0xf
    v_perm_b32 v24, v32, v32, v8
    v_perm_b32 v25, v32, v32, v9
    v_perm_b32 v26, v32, v32, v10
    v_perm_b32 v27, v32, v32, v11
    s_waitcnt vmcnt(12)
    v_mfma_f32_16x16x32_bf16 v[20:23], v[28:31], v[204:207], v[20:23]
    v_mov_b32_dpp v33, v59 row_newbcast:5 row_mask:0xf bank_mask:0xf
    v_perm_b32 v28, v33, v33, v8
    v_perm_b32 v29, v33, v33, v9
    v_perm_b32 v30, v33, v33, v10
    v_perm_b32 v31, v33, v33, v11
    s_waitcnt vmcnt(11)
    v_mfma_f32_16x16x32_bf16 v[20:23], v[24:27], v[208:211], v[20:23]
    v_mov_b32_dpp v32, v59 row_newbcast:6 row_mask:0xf bank_mask:0xf
    v_perm_b32 v24, v32, v32, v8
    v_perm_b32 v25, v32, v32, v9
    v_perm_b32 v26, v32, v32, v10
    v_perm_b32 v27, v32, v32, v11
    s_waitcnt vmcnt(10)
    v_mfma_f32_16x16x32_bf16 v[20:23], v[28:31], v[212:215], v[20:23]
    v_mov_b32_dpp v33, v59 row_newbcast:7 row_mask:0xf bank_mask:0xf
    v_perm_b32 v28, v33, v33, v8
    v_perm_b32 v29, v33, v33, v9
    v_perm_b32 v30, v33, v33, v10
    v_perm_b32 v31, v33, v33, v11
    s_waitcnt vmcnt(9)
    v_mfma_f32_16x16x32_bf16 v[20:23], v[24:27], v[216:219], v[20:23]
    v_mov_b32_dpp v32, v59 row_newbcast:8 row_mask:0xf bank_mask:0xf
    v_perm_b32 v24, v32, v32, v8
    v_perm_b32 v25, v32, v32, v9
    v_perm_b32 v26, v32, v32, v10
    v_perm_b32 v27, v32, v32, v11
    s_waitcnt vmcnt(8)
    v_mfma_f32_16x16x32_bf16 v[20:23], v[28:31], v[220:223], v[20:23]
    v_mov_b32_dpp v33, v59 row_newbcast:9 row_mask:0xf bank_mask:0xf
    v_perm_b32 v28, v33, v33, v8
    v_perm_b32 v29, v33, v33, v9
    v_perm_b32 v30, v33, v33, v10
    v_perm_b32 v31, v33, v33, v11
    s_waitcnt vmcnt(7)
    v_mfma_f32_16x16x32_bf16 v[20:23], v[24:27], v[224:227], v[20:23]
    v_mov_b32_dpp v32, v59 row_newbcast:10 row_mask:0xf bank_mask:0xf
    v_perm_b32 v24, v32, v32, v8
    v_perm_b32 v25, v32, v32, v9
    v_perm_b32 v26, v32, v32, v10
    v_perm_b32 v27, v32, v32, v11
    s_waitcnt vmcnt(6)
    v_mfma_f32_16x16x32_bf16 v[20:23], v[28:31], v[228:231], v[20:23]
    v_mov_b32_dpp v33, v59 row_newbcast:11 row_mask:0xf bank_mask:0xf
    v_perm_b32 v28, v33, v33, v8
    v_perm_b32 v29, v33, v33, v9
    v_perm_b32 v30, v33, v33, v10
    v_perm_b32 v31, v33, v33, v11
    s_waitcnt vmcnt(5)
    v_mfma_f32_16x16x32_bf16 v[20:23], v[24:27], v[232:235], v[20:23]
    v_mov_b32_dpp v32, v59 row_newbcast:12 row_mask:0xf bank_mask:0xf
    v_perm_b32 v24, v32, v32, v8
    v_perm_b32 v25, v32, v32, v9
    v_perm_b32 v26, v32, v32, v10
    v_perm_b32 v27, v32, v32, v11
    s_waitcnt vmcnt(4)
    v_mfma_f32_16x16x32_bf16 v[20:23], v[28:31], v[236:239], v[20:23]
    v_mov_b32_dpp v33, v59 row_newbcast:13 row_mask:0xf bank_mask:0xf
    v_perm_b32 v28, v33, v33, v8
    v_perm_b32 v29, v33, v33, v9
    v_perm_b32 v30, v33, v33, v10
    v_perm_b32 v31, v33, v33, v11
    s_waitcnt vmcnt(3)
    v_mfma_f32_16x16x32_bf16 v[20:23], v[24:27], v[240:243], v[20:23]
    v_mov_b32_dpp v32, v59 row_newbcast:14 row_mask:0xf bank_mask:0xf
    v_perm_b32 v24, v32, v32, v8
    v_perm_b32 v25, v32, v32, v9
    v_perm_b32 v26, v32, v32, v10
    v_perm_b32 v27, v32, v32, v11
    s_waitcnt vmcnt(2)
    v_mfma_f32_16x16x32_bf16 v[20:23], v[28:31], v[244:247], v[20:23]
    v_mov_b32_dpp v33, v59 row_newbcast:15 row_mask:0xf bank_mask:0xf
    v_perm_b32 v28, v33, v33, v8
    v_perm_b32 v29, v33, v33, v9
    v_perm_b32 v30, v33, v33, v10
    v_perm_b32 v31, v33, v33, v11
    s_waitcnt vmcnt(1)
    v_mfma_f32_16x16x32_bf16 v[20:23], v[24:27], v[248:251], v[20:23]
    s_waitcnt vmcnt(0)
    v_mfma_f32_16x16x32_bf16 v[20:23], v[28:31], v[252:255], v[20:23]
    s_nop 7
    v_permlane32_swap_b32 v20, v21
    v_permlane32_swap_b32 v22, v23
    v_add_f32 v20, v20, v21
    v_add_f32 v22, v22, v23
    ds_write_b32 v72, v20 offset:5376
    ds_write_b32 v72, v22 offset:5384
    s_waitcnt lgkmcnt(0)
    s_barrier
    ds_read_b64 v[60:61], v74 offset:5120
    ds_read_b32 v80, v73 offset:5376
    ds_read_b32 v81, v73 offset:5888
    ds_read_b32 v82, v73 offset:6400
    ds_read_b32 v83, v73 offset:6912
    ds_read_b32 v84, v73 offset:7424
    ds_read_b32 v85, v73 offset:7936
    ds_read_b32 v86, v73 offset:8448
    ds_read_b32 v87, v73 offset:8960
    s_waitcnt lgkmcnt(8)
    v_max_f32_dpp v38, v60, v60 quad_perm:[1,0,3,2] row_mask:0xf bank_mask:0xf
    s_nop 1
    v_max_f32_dpp v38, v38, v38 quad_perm:[2,3,0,1] row_mask:0xf bank_mask:0xf
    s_nop 1
    v_max_f32_dpp v38, v38, v38 row_half_mirror row_mask:0xf bank_mask:0xf
    v_sub_f32 v62, v60, v38
    v_mul_f32 v62, s72, v62
    v_exp_f32 v62, v62
    v_mov_b32 v63, 0
    v_mul_f32 v39, v62, v61
    s_waitcnt lgkmcnt(0)
    v_fmac_f32_dpp v63, v62, v80 row_newbcast:0 row_mask:0xf bank_mask:0xf
    s_nop 1
    v_fmac_f32_dpp v63, v62, v81 row_newbcast:1 row_mask:0xf bank_mask:0xf
    s_nop 1
    v_fmac_f32_dpp v63, v62, v82 row_newbcast:2 row_mask:0xf bank_mask:0xf
    s_nop 1
    v_fmac_f32_dpp v63, v62, v83 row_newbcast:3 row_mask:0xf bank_mask:0xf
    s_nop 1
    v_fmac_f32_dpp v63, v62, v84 row_newbcast:4 row_mask:0xf bank_mask:0xf
    s_nop 1
    v_fmac_f32_dpp v63, v62, v85 row_newbcast:5 row_mask:0xf bank_mask:0xf
    s_nop 1
    v_fmac_f32_dpp v63, v62, v86 row_newbcast:6 row_mask:0xf bank_mask:0xf
    s_nop 1
    v_fmac_f32_dpp v63, v62, v87 row_newbcast:7 row_mask:0xf bank_mask:0xf
    v_cvt_pk_bf16_f32 v59, v63, v63
    v_lshlrev_b32 v59, 16, v59
    v_sub_f32 v59, v63, v59
    v_cvt_pk_bf16_f32 v63, v63, v59
    v_add_f32_dpp v39, v39, v39 quad_perm:[1,0,3,2] row_mask:0xf bank_mask:0xf
    s_nop 1
    v_add_f32_dpp v39, v39, v39 quad_perm:[2,3,0,1] row_mask:0xf bank_mask:0xf
    s_nop 1
    v_add_f32_dpp v39, v39, v39 row_half_mirror row_mask:0xf bank_mask:0xf
    v_min_u32 v38, -2, v38
    v_min_u32 v39, -2, v39
    buffer_store_dwordx2 v[38:39], v35, s[40:43], 0 offen sc1
    v_mov_b32_dpp v32, v63 row_newbcast:0 row_mask:0xf bank_mask:0xf
    v_perm_b32 v24, v32, v32, v8
    v_perm_b32 v25, v32, v32, v9
    v_perm_b32 v26, v32, v32, v10
    v_perm_b32 v27, v32, v32, v11
    v_mov_b32_dpp v33, v63 row_newbcast:1 row_mask:0xf bank_mask:0xf
    v_perm_b32 v28, v33, v33, v8
    v_perm_b32 v29, v33, v33, v9
    v_perm_b32 v30, v33, v33, v10
    v_perm_b32 v31, v33, v33, v11
    v_mfma_f32_16x16x32_bf16 v[20:23], v[24:27], v[128:131], 0
    v_mov_b32_dpp v32, v63 row_newbcast:2 row_mask:0xf bank_mask:0xf
    v_perm_b32 v24, v32, v32, v8
    v_perm_b32 v25, v32, v32, v9
    v_perm_b32 v26, v32, v32, v10
    v_perm_b32 v27, v32, v32, v11
    v_mfma_f32_16x16x32_bf16 v[20:23], v[28:31], v[132:135], v[20:23]
    v_mov_b32_dpp v33, v63 row_newbcast:3 row_mask:0xf bank_mask:0xf
    v_perm_b32 v28, v33, v33, v8
    v_perm_b32 v29, v33, v33, v9
    v_perm_b32 v30, v33, v33, v10
    v_perm_b32 v31, v33, v33, v11
    v_mfma_f32_16x16x32_bf16 v[20:23], v[24:27], v[136:139], v[20:23]
    v_mov_b32_dpp v32, v63 row_newbcast:4 row_mask:0xf bank_mask:0xf
    v_perm_b32 v24, v32, v32, v8
    v_perm_b32 v25, v32, v32, v9
    v_perm_b32 v26, v32, v32, v10
    v_perm_b32 v27, v32, v32, v11
    v_mfma_f32_16x16x32_bf16 v[20:23], v[28:31], v[140:143], v[20:23]
    v_mov_b32_dpp v33, v63 row_newbcast:5 row_mask:0xf bank_mask:0xf
    v_perm_b32 v28, v33, v33, v8
    v_perm_b32 v29, v33, v33, v9
    v_perm_b32 v30, v33, v33, v10
    v_perm_b32 v31, v33, v33, v11
    v_mfma_f32_16x16x32_bf16 v[20:23], v[24:27], v[144:147], v[20:23]
    v_mov_b32_dpp v32, v63 row_newbcast:6 row_mask:0xf bank_mask:0xf
    v_perm_b32 v24, v32, v32, v8
    v_perm_b32 v25, v32, v32, v9
    v_perm_b32 v26, v32, v32, v10
    v_perm_b32 v27, v32, v32, v11
    v_mfma_f32_16x16x32_bf16 v[20:23], v[28:31], v[148:151], v[20:23]
    v_mov_b32_dpp v33, v63 row_newbcast:7 row_mask:0xf bank_mask:0xf
    v_perm_b32 v28, v33, v33, v8
    v_perm_b32 v29, v33, v33, v9
    v_perm_b32 v30, v33, v33, v10
    v_perm_b32 v31, v33, v33, v11
    v_mfma_f32_16x16x32_bf16 v[20:23], v[24:27], v[152:155], v[20:23]
    v_mov_b32_dpp v32, v63 row_newbcast:8 row_mask:0xf bank_mask:0xf
    v_perm_b32 v24, v32, v32, v8
    v_perm_b32 v25, v32, v32, v9
    v_perm_b32 v26, v32, v32, v10
    v_perm_b32 v27, v32, v32, v11
    v_mfma_f32_16x16x32_bf16 v[20:23], v[28:31], v[156:159], v[20:23]
    v_mov_b32_dpp v33, v63 row_newbcast:9 row_mask:0xf bank_mask:0xf
    v_perm_b32 v28, v33, v33, v8
    v_perm_b32 v29, v33, v33, v9
    v_perm_b32 v30, v33, v33, v10
    v_perm_b32 v31, v33, v33, v11
    v_mfma_f32_16x16x32_bf16 v[20:23], v[24:27], v[160:163], v[20:23]
    v_mov_b32_dpp v32, v63 row_newbcast:10 row_mask:0xf bank_mask:0xf
    v_perm_b32 v24, v32, v32, v8
    v_perm_b32 v25, v32, v32, v9
    v_perm_b32 v26, v32, v32, v10
    v_perm_b32 v27, v32, v32, v11
    v_mfma_f32_16x16x32_bf16 v[20:23], v[28:31], v[164:167], v[20:23]
    v_mov_b32_dpp v33, v63 row_newbcast:11 row_mask:0xf bank_mask:0xf
    v_perm_b32 v28, v33, v33, v8
    v_perm_b32 v29, v33, v33, v9
    v_perm_b32 v30, v33, v33, v10
    v_perm_b32 v31, v33, v33, v11
    v_mfma_f32_16x16x32_bf16 v[20:23], v[24:27], v[168:171], v[20:23]
    v_mov_b32_dpp v32, v63 row_newbcast:12 row_mask:0xf bank_mask:0xf
    v_perm_b32 v24, v32, v32, v8
    v_perm_b32 v25, v32, v32, v9
    v_perm_b32 v26, v32, v32, v10
    v_perm_b32 v27, v32, v32, v11
    v_mfma_f32_16x16x32_bf16 v[20:23], v[28:31], v[172:175], v[20:23]
    v_mov_b32_dpp v33, v63 row_newbcast:13 row_mask:0xf bank_mask:0xf
    v_perm_b32 v28, v33, v33, v8
    v_perm_b32 v29, v33, v33, v9
    v_perm_b32 v30, v33, v33, v10
    v_perm_b32 v31, v33, v33, v11
    v_mfma_f32_16x16x32_bf16 v[20:23], v[24:27], v[176:179], v[20:23]
    v_mov_b32_dpp v32, v63 row_newbcast:14 row_mask:0xf bank_mask:0xf
    v_perm_b32 v24, v32, v32, v8
    v_perm_b32 v25, v32, v32, v9
    v_perm_b32 v26, v32, v32, v10
    v_perm_b32 v27, v32, v32, v11
    v_mfma_f32_16x16x32_bf16 v[20:23], v[28:31], v[180:183], v[20:23]
    v_mov_b32_dpp v33, v63 row_newbcast:15 row_mask:0xf bank_mask:0xf
    v_perm_b32 v28, v33, v33, v8
    v_perm_b32 v29, v33, v33, v9
    v_perm_b32 v30, v33, v33, v10
    v_perm_b32 v31, v33, v33, v11
    v_mfma_f32_16x16x32_bf16 v[20:23], v[24:27], v[184:187], v[20:23]
    s_nop 0
    v_mfma_f32_16x16x32_bf16 v[20:23], v[28:31], v[188:191], v[20:23]
    s_nop 7
    v_permlane32_swap_b32 v20, v21
    v_permlane32_swap_b32 v22, v23
    v_add_f32 v20, v20, v21
    v_add_f32 v22, v22, v23
    ds_write_b32 v72, v20 offset:9472
    ds_write_b32 v72, v22 offset:9480
    s_waitcnt lgkmcnt(0)
    s_barrier
    ds_read_b128 v[60:63], v75 offset:9472
    ds_read_b128 v[64:67], v75 offset:11520
    s_waitcnt lgkmcnt(0)
    v_add_f32 v60, v60, v64
    v_add_f32 v61, v61, v65
    v_add_f32 v62, v62, v66
    v_add_f32 v63, v63, v67
    v_min_u32 v60, -2, v60
    v_min_u32 v61, -2, v61
    v_min_u32 v62, -2, v62
    v_min_u32 v63, -2, v63
    buffer_store_dwordx4 v[60:63], v34, s[40:43], 0 offen sc1
    s_cmp_eq_u32 s79, 0
    s_cbranch_scc1 L_end
    s_mov_b32 s57, s3
    s_lshr_b32 s62, s57, 5
    s_and_b32 s63, s57, 31
    s_lshl_b32 s63, s63, 4
    v_lshrrev_b32 v68, 2, v0
    v_and_b32 v69, 3, v0
    s_lshl_b32 s68, s62, 18
    s_lshl_b32 s77, s63, 2
    s_add_u32 s68, s68, s77
    v_lshlrev_b32 v70, 11, v68
    v_lshl_add_u32 v70, v69, 4, v70
    v_add_u32 v70, s68, v70
    s_lshl_b32 s68, s62, 10
    s_add_u32 s68, s68, 0x1b0000
    v_lshlrev_b32 v71, 3, v68
    v_add_u32 v71, s68, v71
    s_lshl_b32 s68, s62, 11
    s_add_u32 s68, s68, s77
    s_add_u32 s68, s68, 0x100000
    v_lshlrev_b32 v72, 12, v68
    v_lshl_add_u32 v72, v69, 4, v72
    v_add_u32 v72, s68, v72
    v_add_u32 v73, 0x80000, v72
    v_mov_b32 v77, 0x80000000
    v_cmp_gt_u32 vcc, 44, v68
    s_nop 1
    v_cndmask_b32 v73, v77, v73, vcc
    s_lshl_b32 s68, s62, 10
    s_lshl_b32 s77, s63, 1
    s_add_u32 s68, s68, s77
    v_lshlrev_b32 v74, 1, v6
    v_add_u32 v74, s68, v74
    buffer_load_ushort v76, v74, s[4:7], 0 offen
    s_movk_i32 s68, 252
    s_mov_b32 s77, 0
L_sp8:
    buffer_load_dword v19, v3, s[36:39], s68 offen sc1
    s_waitcnt vmcnt(0)
L_sc8:
    v_readfirstlane_b32 s61, v19
    s_add_u32 s77, s77, 1
    s_cmp_gt_u32 s77, 400000
    s_cbranch_scc1 L_sd8
    s_cmp_lt_u32 s61, 256
    s_cbranch_scc1 L_sp8
L_sd8:
    buffer_load_dwordx4 v[80:83], v72, s[40:43], 0 offen sc1
    buffer_load_dwordx4 v[84:87], v73, s[40:43], 0 offen sc1
    s_waitcnt vmcnt(0)
    v_add_f32 v80, v80, v84
    v_add_f32 v81, v81, v85
    v_add_f32 v82, v82, v86
    v_add_f32 v83, v83, v87
    s_nop 0
    v_permlane32_swap_b32 v80, v82
    v_permlane32_swap_b32 v81, v83
    v_add_f32 v80, v80, v82
    v_add_f32 v81, v81, v83
    s_nop 1
    v_permlane16_swap_b32 v80, v81
    v_add_f32 v80, v80, v81
    s_nop 1
    v_add_f32_dpp v80, v80, v80 row_ror:4 row_mask:0xf bank_mask:0xf
    s_nop 1
    v_add_f32_dpp v80, v80, v80 row_ror:8 row_mask:0xf bank_mask:0xf
    v_lshl_add_u32 v79, v69, 2, v5
    v_lshlrev_b32 v79, 5, v79
    s_lshl_b32 s68, s54, 2
    v_add_u32 v79, s68, v79
    ds_write_b32 v79, v80 offset:14080
    s_mov_b32 s77, 0
    s_nop 7
L_y:
    buffer_load_dwordx4 v[88:91], v70, s[40:43], 0 offen sc1
    buffer_load_dwordx2 v[92:93], v71, s[40:43], 0 offen sc1
    s_add_u32 s77, s77, 1
    s_waitcnt vmcnt(0)
    v_max3_u32 v78, v88, v89, v90
    v_max3_u32 v78, v78, v91, v92
    v_max_u32 v78, v78, v93
    v_cmp_eq_u32 vcc, -1, v78
    s_cmp_gt_u32 s77, 400000
    s_cbranch_scc1 L_y_done
    s_cmp_lg_u64 vcc, 0
    s_cbranch_scc1 L_y
    s_nop 7
L_y_done:
    v_max_f32_dpp v94, v92, v92 row_ror:4 row_mask:0xf bank_mask:0xf
    s_nop 1
    v_max_f32_dpp v94, v94, v94 row_ror:8 row_mask:0xf bank_mask:0xf
    v_sub_f32 v95, v92, v94
    v_mul_f32 v95, s72, v95
    v_exp_f32 v95, v95
    s_nop 0
    v_mul_f32 v96, v95, v93
    s_nop 1
    v_add_f32_dpp v96, v96, v96 row_ror:4 row_mask:0xf bank_mask:0xf
    s_nop 1
    v_add_f32_dpp v96, v96, v96 row_ror:8 row_mask:0xf bank_mask:0xf
    v_rcp_f32 v96, v96
    s_nop 0
    v_mul_f32 v95, v95, v96
    v_mul_f32 v88, v88, v95
    v_mul_f32 v89, v89, v95
    v_mul_f32 v90, v90, v95
    v_mul_f32 v91, v91, v95
    s_nop 0
    v_permlane32_swap_b32 v88, v90
    v_permlane32_swap_b32 v89, v91
    v_add_f32 v88, v88, v90
    v_add_f32 v89, v89, v91
    s_nop 1
    v_permlane16_swap_b32 v88, v89
    v_add_f32 v88, v88, v89
    s_nop 1
    v_add_f32_dpp v88, v88, v88 row_ror:4 row_mask:0xf bank_mask:0xf
    s_nop 1
    v_add_f32_dpp v88, v88, v88 row_ror:8 row_mask:0xf bank_mask:0xf
    ds_write_b32 v79, v88 offset:13568
    s_waitcnt lgkmcnt(0)
    s_barrier
    s_cmp_lg_u32 s54, 0
    s_cbranch_scc1 L_end
    v_lshlrev_b32 v79, 5, v6
    ds_read_b128 v[80:83], v79 offset:13568
    ds_read_b128 v[84:87], v79 offset:13584
    ds_read_b128 v[88:91], v79 offset:14080
    ds_read_b128 v[92:95], v79 offset:14096
    s_waitcnt lgkmcnt(0)
    v_add_f32 v80, v80, v81
    v_add_f32 v82, v82, v83
    v_add_f32 v84, v84, v85
    v_add_f32 v86, v86, v87
    v_add_f32 v88, v88, v89
    v_add_f32 v90, v90, v91
    v_add_f32 v92, v92, v93
    v_add_f32 v94, v94, v95
    v_add_f32 v80, v80, v82
    v_add_f32 v84, v84, v86
    v_add_f32 v88, v88, v90
    v_add_f32 v92, v92, v94
    v_add_f32 v80, v80, v84
    v_add_f32 v88, v88, v92
    v_cvt_pk_bf16_f32 v81, v80, v88
    v_lshlrev_b32 v80, 16, v81
    v_and_b32 v88, s74, v81
    v_mul_f32 v82, 0xbfb8aa3b, v88
    v_exp_f32 v82, v82
    s_nop 0
    v_add_f32 v82, 1.0, v82
    v_rcp_f32 v82, v82
    s_nop 0
    v_mul_f32 v82, v82, v88
    v_cvt_pk_bf16_f32 v81, v82, v82
    v_lshlrev_b32 v82, 16, v81
    v_mul_f32 v80, v80, v82
    v_cvt_pk_bf16_f32 v81, v80, v80
    v_lshlrev_b32 v80, 16, v81
    v_lshlrev_b32 v76, 16, v76
    v_add_f32 v80, v80, v76
    v_cvt_pk_bf16_f32 v81, v80, v80
    s_mov_b64 exec, 0xffff
    buffer_store_short v81, v74, s[32:35], 0 offen
    s_cmp_lg_u32 s3, 0
    s_cbranch_scc1 L_noep
    v_mov_b32 v96, s56
    s_mov_b32 s61, 0x1b8000
    s_mov_b64 exec, 1
    buffer_store_dword v96, v3, s[40:43], s61 offen
L_noep:
    s_mov_b64 exec, -1
L_end:
L_exit:
    s_endpgm
.section .rodata,"a"
.p2align 6
.amdhsa_kernel recurrent_scan__mha_block_cached__geglu_ffn__decode_kernel
  .amdhsa_next_free_vgpr 256
  .amdhsa_next_free_sgpr 102
  .amdhsa_accum_offset 256
  .amdhsa_group_segment_fixed_size 0
  .amdhsa_kernarg_size 96
  .amdhsa_user_sgpr_count 2
  .amdhsa_user_sgpr_kernarg_segment_ptr 1
  .amdhsa_system_sgpr_workgroup_id_x 1
  .amdhsa_float_denorm_mode_32 3
.end_amdhsa_kernel
```
